```python
import torch

def _softmax(x, axis=-1):
    return torch.softmax(x, dim=axis)
def _gelu(x):
    return torch.nn.functional.gelu(x, approximate="tanh")
def _silu(x):
    return torch.nn.functional.silu(x)
def _sigmoid(x):
    return torch.sigmoid(x)
def _layernorm(x, axis=-1, eps=1e-5):
    m = x.mean(dim=axis, keepdim=True)
    v = x.var(dim=axis, keepdim=True, unbiased=False)
    return (x - m) / torch.sqrt(v + eps)
def _scatter_add(tgt, idx, src, axis=0):
    return tgt.clone().index_add_(axis, idx, src)
def _segment_sum(src, seg, n):
    out = torch.zeros((n,) + src.shape[1:], dtype=src.dtype)
    return out.index_add_(0, seg, src)
def _pad(x, pw):
    flat = tuple(v for pair in reversed(pw) for v in pair)
    return torch.nn.functional.pad(x, flat)

kernel_name = 'sequential_preLN__sliding_block_cached__glu_gated_bilinear__decode'

def setup_inputs():

    _w = (lambda a: (lambda t: t.to(torch.bfloat16) if t.is_floating_point() else t)(torch.as_tensor(a)))
    def _A_setup():
        B, Sq, D = 1, 1, 576
        Hq, Hkv, Sk, Dh = 32, 16, 65536, 128
        assert Hq % Hkv == 0, (Hq, Hkv)
        return {
            "x": _w((lambda *s: torch.randn(*s, dtype=torch.bfloat16) * 0.05)(B, Sq, D)),
            "k_cache": _w((lambda *s: torch.randn(*s, dtype=torch.bfloat16) * 1.6)(B, Hkv, Sk, Dh)),
            "v_cache": _w((lambda *s: torch.randn(*s, dtype=torch.bfloat16) * 0.8)(B, Hkv, Sk, Dh)),
            "wq": _w((lambda *s: torch.randn(*s, dtype=torch.bfloat16) * 1.6)(D, Hq * Dh) * (D ** -0.5)),
            "wo": _w((lambda *s: torch.randn(*s, dtype=torch.bfloat16) * 0.8)(Hq * Dh, D) * ((Hq * Dh) ** -0.5)),
        }
    _A_in = _A_setup()

    def _B_setup():
        B, S, D, F = 1, 1, 576, 4608
        return {
            "x": _w((lambda *s: torch.randn(*s, dtype=torch.bfloat16) * 0.05)(B, S, D)),
            "w_gate": _w((lambda *s: torch.randn(*s, dtype=torch.bfloat16) * 0.4)(D, F) * (D ** -0.5)),
            "w_up": _w((lambda *s: torch.randn(*s, dtype=torch.bfloat16) * 0.4)(D, F) * (D ** -0.5)),
            "w_down": _w((lambda *s: torch.randn(*s, dtype=torch.bfloat16) * 0.4)(F, D) * (F ** -0.5)),
        }
    _B_in = _B_setup()

    return {
        "A_x": _A_in["x"],
        "A_k_cache": _A_in["k_cache"],
        "A_v_cache": _A_in["v_cache"],
        "A_wq": _A_in["wq"],
        "A_wo": _A_in["wo"],
        "B_x": _B_in["x"],
        "B_w_gate": _B_in["w_gate"],
        "B_w_up": _B_in["w_up"],
        "B_w_down": _B_in["w_down"],
    }

def reference(A_x, A_k_cache, A_v_cache, A_wq, A_wo, B_x, B_w_gate, B_w_up, B_w_down):
    def _A_ref(x, k_cache, v_cache, wq, wo):
        B, Sq, D = x.shape
        Hq, Dh = 32, 128
        Hkv, Sk = k_cache.shape[1], k_cache.shape[2]
        W = min(4096, max(256, Sk // 4))
        rep = Hq // Hkv
        q = (lambda x, *d: x.permute(*d))((x @ wq).reshape(B, Sq, Hq, Dh), 0, 2, 1, 3)
        k = (lambda x, n, axis: torch.repeat_interleave(x, n, dim=axis))(k_cache[:, :, Sk - W:, :], rep, axis=1)
        v = (lambda x, n, axis: torch.repeat_interleave(x, n, dim=axis))(v_cache[:, :, Sk - W:, :], rep, axis=1)
        scores = torch.einsum("bhqd,bhkd->bhqk", q, k) * (Dh ** -0.5)
        p = _softmax(scores, axis=-1)
        o = torch.einsum("bhqk,bhkd->bhqd", p, v)
        return (lambda x, *d: x.permute(*d))(o, 0, 2, 1, 3).reshape(B, Sq, Hq * Dh) @ wo

    def _B_ref(x, w_gate, w_up, w_down):
        g = torch.einsum("bsd,df->bsf", x, w_gate)
        u = torch.einsum("bsd,df->bsf", x, w_up)
        h = g * u
        return torch.einsum("bsf,fd->bsd", h, w_down)

    x = A_x
    h = x + _A_ref(_layernorm(x, axis=-1), A_k_cache, A_v_cache, A_wq, A_wo)
    h2 = h + _B_ref(_layernorm(h, axis=-1), B_w_gate, B_w_up, B_w_down)
    return h2
```

```asm
; @launch grid=(256,1,1) block=(768,1,1) lds=163840
.amdgcn_target "amdgcn-amd-amdhsa--gfx950"
.text
.globl sequential_preLN__sliding_block_cached__glu_gated_bilinear__decode_kernel
.p2align 8
.type sequential_preLN__sliding_block_cached__glu_gated_bilinear__decode_kernel,@function
sequential_preLN__sliding_block_cached__glu_gated_bilinear__decode_kernel:
    s_cmp_ge_u32 s2, 256
    s_cbranch_scc1 L_end
    s_load_dwordx16 s[4:19], s[0:1], 0
    s_load_dwordx8 s[20:27], s[0:1], 64
    v_and_b32 v1, 63, v0
    v_lshrrev_b32 v4, 6, v0
    v_mov_b32 v2, 152384
    v_readfirstlane_b32 s30, v4
    v_mov_b32 v3, 1
    s_and_b32 s28, s2, 7
    s_lshr_b32 s34, s2, 3
    s_lshl_b32 s29, s28, 1
    s_and_b32 s32, s34, 1
    s_add_u32 s29, s29, s32
    s_lshr_b32 s35, s2, 4
    s_mov_b32 s57, 200000
    s_mov_b32 s58, 20000
    v_lshl_add_u32 v4, v1, 2, v2
    v_mov_b32 v5, 0
    ds_write_b32 v4, v5
    s_waitcnt lgkmcnt(0)

    s_cmp_ge_u32 s30, 4
    s_cbranch_scc1 L_compute

    s_setprio 0
    s_lshl_b32 s32, s29, 24
    s_add_u32 s32, s32, 15728640
    s_lshl_b32 s33, s35, 16
    s_add_u32 s32, s32, s33
    s_add_u32 s36, s6, s32
    s_addc_u32 s37, s7, 0
    s_mov_b32 s38, 65536
    s_mov_b32 s39, 0x20000
    s_add_u32 s40, s8, s32
    s_addc_u32 s41, s9, 0
    s_mov_b32 s42, 65536
    s_mov_b32 s43, 0x20000

    s_mov_b32 s44, s10
    s_mov_b32 s45, s11
    s_mov_b32 s46, 4718592
    s_mov_b32 s47, 0x20000
    v_lshrrev_b32 v6, 3, v1
    v_lshlrev_b32 v10, 13, v6
    v_lshrrev_b32 v7, 4, v1
    v_and_b32 v7, 3, v7
    v_lshlrev_b32 v7, 1, v7
    v_and_b32 v8, 7, v1
    v_xor_b32 v8, v8, v7
    v_lshlrev_b32 v8, 4, v8
    v_add_u32 v10, v10, v8
    s_lshr_b32 s32, s35, 2
    s_mul_i32 s32, s32, 1179648
    s_lshl_b32 s33, s29, 9
    s_add_u32 s32, s32, s33
    s_and_b32 s33, s35, 3
    s_lshl_b32 s33, s33, 7
    s_add_u32 s48, s32, s33
    s_lshl_b32 s33, s30, 16
    s_add_u32 s48, s48, s33
    s_lshl_b32 s49, s30, 10

    s_add_u32 s33, s48, 0
    s_add_u32 m0, s49, 131072
    s_nop 0
    buffer_load_dwordx4 v10, s[44:47], s33 offen nt lds
    s_add_u32 s33, s48, 262144
    s_add_u32 m0, s49, 135168
    s_nop 0
    buffer_load_dwordx4 v10, s[44:47], s33 offen nt lds
    s_add_u32 s33, s48, 524288
    s_add_u32 m0, s49, 139264
    s_nop 0
    buffer_load_dwordx4 v10, s[44:47], s33 offen nt lds
    s_add_u32 s33, s48, 786432
    s_add_u32 m0, s49, 143360
    s_nop 0
    buffer_load_dwordx4 v10, s[44:47], s33 offen nt lds
    s_cmp_lt_u32 s30, 2
    s_cbranch_scc0 Lwq_1
    s_add_u32 s33, s48, 1048576
    s_add_u32 m0, s49, 147456
    s_nop 0
    buffer_load_dwordx4 v10, s[44:47], s33 offen nt lds
Lwq_1:
    s_barrier
    v_lshrrev_b32 v6, 4, v1
    v_and_b32 v7, 15, v1
    s_lshl_b32 s32, s30, 2
    v_add_u32 v9, s32, v6
    v_xor_b32 v9, v9, v7
    v_lshlrev_b32 v9, 4, v9
    v_lshl_add_u32 v11, v6, 8, v9
    s_and_b32 s32, s30, 1
    s_lshl_b32 s32, s32, 2
    v_add_u32 v9, s32, v6
    v_lshlrev_b32 v9, 1, v9
    v_xor_b32 v9, v9, v7
    v_lshlrev_b32 v9, 4, v9
    v_lshl_add_u32 v12, v6, 8, v9
    s_mul_i32 s50, s2, 13
    s_add_u32 s50, s50, s30

    s_cmp_lt_u32 s34, 18
    s_cbranch_scc1 L_kv_std
    s_cmp_lt_u32 s34, 27
    s_cbranch_scc1 L_kv_wo
L_kv_std:

    s_waitcnt vmcnt(4)
    s_add_u32 s33, s50, 0
    s_and_b32 s33, s33, 63
    s_lshl_b32 s33, s33, 10
    s_add_u32 m0, s49, 0
    s_nop 0
    buffer_load_dwordx4 v11, s[36:39], s33 offen nt lds
    s_waitcnt vmcnt(4)
    s_add_u32 s33, s50, 4
    s_and_b32 s33, s33, 63
    s_lshl_b32 s33, s33, 10
    s_add_u32 m0, s49, 4096
    s_nop 0
    buffer_load_dwordx4 v11, s[36:39], s33 offen nt lds
    s_waitcnt vmcnt(4)
    s_add_u32 s33, s50, 8
    s_and_b32 s33, s33, 63
    s_lshl_b32 s33, s33, 10
    s_add_u32 m0, s49, 8192
    s_nop 0
    buffer_load_dwordx4 v11, s[36:39], s33 offen nt lds
    s_waitcnt vmcnt(4)
    s_add_u32 s33, s50, 12
    s_and_b32 s33, s33, 63
    s_lshl_b32 s33, s33, 10
    s_add_u32 m0, s49, 12288
    s_nop 0
    buffer_load_dwordx4 v11, s[36:39], s33 offen nt lds
    s_waitcnt vmcnt(4)
    s_mov_b64 exec, 1
    ds_add_u32 v2, v3 offset:0
    s_mov_b64 exec, -1

    s_add_u32 s33, s50, 16
    s_and_b32 s33, s33, 63
    s_lshl_b32 s33, s33, 10
    s_add_u32 m0, s49, 16384
    s_nop 0
    buffer_load_dwordx4 v11, s[36:39], s33 offen nt lds
    s_waitcnt vmcnt(4)
    s_add_u32 s33, s50, 20
    s_and_b32 s33, s33, 63
    s_lshl_b32 s33, s33, 10
    s_add_u32 m0, s49, 20480
    s_nop 0
    buffer_load_dwordx4 v11, s[36:39], s33 offen nt lds
    s_waitcnt vmcnt(4)
    s_add_u32 s33, s50, 24
    s_and_b32 s33, s33, 63
    s_lshl_b32 s33, s33, 10
    s_add_u32 m0, s49, 24576
    s_nop 0
    buffer_load_dwordx4 v11, s[36:39], s33 offen nt lds
    s_waitcnt vmcnt(4)
    s_add_u32 s33, s50, 28
    s_and_b32 s33, s33, 63
    s_lshl_b32 s33, s33, 10
    s_add_u32 m0, s49, 28672
    s_nop 0
    buffer_load_dwordx4 v11, s[36:39], s33 offen nt lds
    s_waitcnt vmcnt(4)
    s_mov_b64 exec, 1
    ds_add_u32 v2, v3 offset:12
    s_mov_b64 exec, -1

    s_add_u32 s33, s50, 32
    s_and_b32 s33, s33, 63
    s_lshl_b32 s33, s33, 10
    s_add_u32 m0, s49, 32768
    s_nop 0
    buffer_load_dwordx4 v11, s[36:39], s33 offen nt lds
    s_waitcnt vmcnt(4)
    s_add_u32 s33, s50, 36
    s_and_b32 s33, s33, 63
    s_lshl_b32 s33, s33, 10
    s_add_u32 m0, s49, 36864
    s_nop 0
    buffer_load_dwordx4 v11, s[36:39], s33 offen nt lds
    s_waitcnt vmcnt(4)
    s_add_u32 s33, s50, 40
    s_and_b32 s33, s33, 63
    s_lshl_b32 s33, s33, 10
    s_add_u32 m0, s49, 40960
    s_nop 0
    buffer_load_dwordx4 v11, s[36:39], s33 offen nt lds
    s_waitcnt vmcnt(4)
    s_add_u32 s33, s50, 44
    s_and_b32 s33, s33, 63
    s_lshl_b32 s33, s33, 10
    s_add_u32 m0, s49, 45056
    s_nop 0
    buffer_load_dwordx4 v11, s[36:39], s33 offen nt lds
    s_waitcnt vmcnt(4)
    s_mov_b64 exec, 1
    ds_add_u32 v2, v3 offset:16
    s_mov_b64 exec, -1

    s_add_u32 s33, s50, 48
    s_and_b32 s33, s33, 63
    s_lshl_b32 s33, s33, 10
    s_add_u32 m0, s49, 49152
    s_nop 0
    buffer_load_dwordx4 v11, s[36:39], s33 offen nt lds
    s_waitcnt vmcnt(4)
    s_add_u32 s33, s50, 52
    s_and_b32 s33, s33, 63
    s_lshl_b32 s33, s33, 10
    s_add_u32 m0, s49, 53248
    s_nop 0
    buffer_load_dwordx4 v11, s[36:39], s33 offen nt lds
    s_waitcnt vmcnt(4)
    s_add_u32 s33, s50, 56
    s_and_b32 s33, s33, 63
    s_lshl_b32 s33, s33, 10
    s_add_u32 m0, s49, 57344
    s_nop 0
    buffer_load_dwordx4 v11, s[36:39], s33 offen nt lds
    s_waitcnt vmcnt(4)
    s_add_u32 s33, s50, 60
    s_and_b32 s33, s33, 63
    s_lshl_b32 s33, s33, 10
    s_add_u32 m0, s49, 61440
    s_nop 0
    buffer_load_dwordx4 v11, s[36:39], s33 offen nt lds
    s_waitcnt vmcnt(4)
    s_mov_b64 exec, 1
    ds_add_u32 v2, v3 offset:20
    s_mov_b64 exec, -1

    s_add_u32 s33, s50, 0
    s_and_b32 s33, s33, 63
    s_lshl_b32 s33, s33, 10
    s_add_u32 m0, s49, 65536
    s_nop 0
    buffer_load_dwordx4 v12, s[40:43], s33 offen nt lds
    s_waitcnt vmcnt(4)
    s_add_u32 s33, s50, 4
    s_and_b32 s33, s33, 63
    s_lshl_b32 s33, s33, 10
    s_add_u32 m0, s49, 69632
    s_nop 0
    buffer_load_dwordx4 v12, s[40:43], s33 offen nt lds
    s_waitcnt vmcnt(4)
    s_add_u32 s33, s50, 8
    s_and_b32 s33, s33, 63
    s_lshl_b32 s33, s33, 10
    s_add_u32 m0, s49, 73728
    s_nop 0
    buffer_load_dwordx4 v12, s[40:43], s33 offen nt lds
    s_waitcnt vmcnt(4)
    s_add_u32 s33, s50, 12
    s_and_b32 s33, s33, 63
    s_lshl_b32 s33, s33, 10
    s_add_u32 m0, s49, 77824
    s_nop 0
    buffer_load_dwordx4 v12, s[40:43], s33 offen nt lds
    s_waitcnt vmcnt(4)
    s_mov_b64 exec, 1
    ds_add_u32 v2, v3 offset:24
    s_mov_b64 exec, -1

    s_add_u32 s33, s50, 16
    s_and_b32 s33, s33, 63
    s_lshl_b32 s33, s33, 10
    s_add_u32 m0, s49, 81920
    s_nop 0
    buffer_load_dwordx4 v12, s[40:43], s33 offen nt lds
    s_waitcnt vmcnt(4)
    s_add_u32 s33, s50, 20
    s_and_b32 s33, s33, 63
    s_lshl_b32 s33, s33, 10
    s_add_u32 m0, s49, 86016
    s_nop 0
    buffer_load_dwordx4 v12, s[40:43], s33 offen nt lds
    s_waitcnt vmcnt(4)
    s_add_u32 s33, s50, 24
    s_and_b32 s33, s33, 63
    s_lshl_b32 s33, s33, 10
    s_add_u32 m0, s49, 90112
    s_nop 0
    buffer_load_dwordx4 v12, s[40:43], s33 offen nt lds
    s_waitcnt vmcnt(4)
    s_add_u32 s33, s50, 28
    s_and_b32 s33, s33, 63
    s_lshl_b32 s33, s33, 10
    s_add_u32 m0, s49, 94208
    s_nop 0
    buffer_load_dwordx4 v12, s[40:43], s33 offen nt lds
    s_waitcnt vmcnt(4)
    s_mov_b64 exec, 1
    ds_add_u32 v2, v3 offset:40
    s_mov_b64 exec, -1

    s_add_u32 s33, s50, 32
    s_and_b32 s33, s33, 63
    s_lshl_b32 s33, s33, 10
    s_add_u32 m0, s49, 98304
    s_nop 0
    buffer_load_dwordx4 v12, s[40:43], s33 offen nt lds
    s_waitcnt vmcnt(4)
    s_add_u32 s33, s50, 36
    s_and_b32 s33, s33, 63
    s_lshl_b32 s33, s33, 10
    s_add_u32 m0, s49, 102400
    s_nop 0
    buffer_load_dwordx4 v12, s[40:43], s33 offen nt lds
    s_waitcnt vmcnt(4)
    s_add_u32 s33, s50, 40
    s_and_b32 s33, s33, 63
    s_lshl_b32 s33, s33, 10
    s_add_u32 m0, s49, 106496
    s_nop 0
    buffer_load_dwordx4 v12, s[40:43], s33 offen nt lds
    s_waitcnt vmcnt(4)
    s_add_u32 s33, s50, 44
    s_and_b32 s33, s33, 63
    s_lshl_b32 s33, s33, 10
    s_add_u32 m0, s49, 110592
    s_nop 0
    buffer_load_dwordx4 v12, s[40:43], s33 offen nt lds
    s_waitcnt vmcnt(4)
    s_mov_b64 exec, 1
    ds_add_u32 v2, v3 offset:44
    s_mov_b64 exec, -1

    s_add_u32 s33, s50, 48
    s_and_b32 s33, s33, 63
    s_lshl_b32 s33, s33, 10
    s_add_u32 m0, s49, 114688
    s_nop 0
    buffer_load_dwordx4 v12, s[40:43], s33 offen nt lds
    s_waitcnt vmcnt(4)
    s_add_u32 s33, s50, 52
    s_and_b32 s33, s33, 63
    s_lshl_b32 s33, s33, 10
    s_add_u32 m0, s49, 118784
    s_nop 0
    buffer_load_dwordx4 v12, s[40:43], s33 offen nt lds
    s_waitcnt vmcnt(4)
    s_add_u32 s33, s50, 56
    s_and_b32 s33, s33, 63
    s_lshl_b32 s33, s33, 10
    s_add_u32 m0, s49, 122880
    s_nop 0
    buffer_load_dwordx4 v12, s[40:43], s33 offen nt lds
    s_waitcnt vmcnt(4)
    s_add_u32 s33, s50, 60
    s_and_b32 s33, s33, 63
    s_lshl_b32 s33, s33, 10
    s_add_u32 m0, s49, 126976
    s_nop 0
    buffer_load_dwordx4 v12, s[40:43], s33 offen nt lds
    s_cmp_lt_u32 s34, 18
    s_cbranch_scc1 L_ld_ffn

Lsp_2:
    ds_read_b32 v4, v2 offset:32
    s_waitcnt lgkmcnt(0)
    v_readfirstlane_b32 s59, v4
    s_cmp_ge_u32 s59, 8
    s_cbranch_scc1 Lspx_3
    s_cmp_eq_u32 s57, 0
    s_cbranch_scc1 Lspx_3
    s_sub_u32 s57, s57, 1
    s_sleep 1
    s_branch Lsp_2
Lspx_3:

    s_waitcnt vmcnt(4)
    s_mov_b64 exec, 1
    ds_add_u32 v2, v3 offset:48
    s_mov_b64 exec, -1

    s_waitcnt vmcnt(0)
    s_mov_b64 exec, 1
    ds_add_u32 v2, v3 offset:52
    s_mov_b64 exec, -1

Lsp_4:
    ds_read_b32 v4, v2 offset:60
    s_waitcnt lgkmcnt(0)
    v_readfirstlane_b32 s59, v4
    s_cmp_ge_u32 s59, 8
    s_cbranch_scc1 Lspx_5
    s_cmp_eq_u32 s57, 0
    s_cbranch_scc1 Lspx_5
    s_sub_u32 s57, s57, 1
    s_sleep 1
    s_branch Lsp_4
Lspx_5:

    v_lshlrev_b32 v13, 4, v1
    s_sub_u32 s51, s34, 27
    s_mov_b32 s44, s20
    s_mov_b32 s45, s21
    s_mov_b32 s46, 5308416
    s_mov_b32 s47, 0x20000
    s_mul_i32 s48, s28, 663552
    s_mul_i32 s32, s51, 133120
    s_add_u32 s48, s48, s32
    s_lshl_b32 s32, s30, 10
    s_add_u32 s48, s48, s32

    s_waitcnt vmcnt(7)
    s_add_u32 s33, s48, 0
    s_add_u32 m0, s49, 0
    s_nop 0
    buffer_load_dwordx4 v13, s[44:47], s33 offen nt lds
    s_waitcnt vmcnt(7)
    s_add_u32 s33, s48, 4096
    s_add_u32 m0, s49, 4096
    s_nop 0
    buffer_load_dwordx4 v13, s[44:47], s33 offen nt lds
    s_waitcnt vmcnt(7)
    s_add_u32 s33, s48, 8192
    s_add_u32 m0, s49, 8192
    s_nop 0
    buffer_load_dwordx4 v13, s[44:47], s33 offen nt lds
    s_waitcnt vmcnt(7)
    s_add_u32 s33, s48, 12288
    s_add_u32 m0, s49, 12288
    s_nop 0
    buffer_load_dwordx4 v13, s[44:47], s33 offen nt lds
    s_waitcnt vmcnt(7)
    s_add_u32 s33, s48, 16384
    s_add_u32 m0, s49, 16384
    s_nop 0
    buffer_load_dwordx4 v13, s[44:47], s33 offen nt lds
    s_waitcnt vmcnt(7)
    s_add_u32 s33, s48, 20480
    s_add_u32 m0, s49, 20480
    s_nop 0
    buffer_load_dwordx4 v13, s[44:47], s33 offen nt lds
    s_waitcnt vmcnt(7)
    s_add_u32 s33, s48, 24576
    s_add_u32 m0, s49, 24576
    s_nop 0
    buffer_load_dwordx4 v13, s[44:47], s33 offen nt lds
    s_waitcnt vmcnt(7)
    s_add_u32 s33, s48, 28672
    s_add_u32 m0, s49, 28672
    s_nop 0
    buffer_load_dwordx4 v13, s[44:47], s33 offen nt lds
    s_waitcnt vmcnt(7)
    s_add_u32 s33, s48, 32768
    s_add_u32 m0, s49, 0
    s_nop 0
    buffer_load_dwordx4 v13, s[44:47], s33 offen nt lds
    s_waitcnt vmcnt(7)
    s_add_u32 s33, s48, 36864
    s_add_u32 m0, s49, 4096
    s_nop 0
    buffer_load_dwordx4 v13, s[44:47], s33 offen nt lds
    s_waitcnt vmcnt(7)
    s_add_u32 s33, s48, 40960
    s_add_u32 m0, s49, 8192
    s_nop 0
    buffer_load_dwordx4 v13, s[44:47], s33 offen nt lds
    s_waitcnt vmcnt(7)
    s_add_u32 s33, s48, 45056
    s_add_u32 m0, s49, 12288
    s_nop 0
    buffer_load_dwordx4 v13, s[44:47], s33 offen nt lds
    s_waitcnt vmcnt(7)
    s_add_u32 s33, s48, 49152
    s_add_u32 m0, s49, 16384
    s_nop 0
    buffer_load_dwordx4 v13, s[44:47], s33 offen nt lds
    s_waitcnt vmcnt(7)
    s_add_u32 s33, s48, 53248
    s_add_u32 m0, s49, 20480
    s_nop 0
    buffer_load_dwordx4 v13, s[44:47], s33 offen nt lds
    s_waitcnt vmcnt(7)
    s_add_u32 s33, s48, 57344
    s_add_u32 m0, s49, 24576
    s_nop 0
    buffer_load_dwordx4 v13, s[44:47], s33 offen nt lds
    s_waitcnt vmcnt(7)
    s_add_u32 s33, s48, 61440
    s_add_u32 m0, s49, 28672
    s_nop 0
    buffer_load_dwordx4 v13, s[44:47], s33 offen nt lds
    s_waitcnt vmcnt(7)
    s_add_u32 s33, s48, 65536
    s_add_u32 m0, s49, 0
    s_nop 0
    buffer_load_dwordx4 v13, s[44:47], s33 offen nt lds
    s_waitcnt vmcnt(7)
    s_add_u32 s33, s48, 69632
    s_add_u32 m0, s49, 4096
    s_nop 0
    buffer_load_dwordx4 v13, s[44:47], s33 offen nt lds
    s_waitcnt vmcnt(7)
    s_add_u32 s33, s48, 73728
    s_add_u32 m0, s49, 8192
    s_nop 0
    buffer_load_dwordx4 v13, s[44:47], s33 offen nt lds
    s_waitcnt vmcnt(7)
    s_add_u32 s33, s48, 77824
    s_add_u32 m0, s49, 12288
    s_nop 0
    buffer_load_dwordx4 v13, s[44:47], s33 offen nt lds
    s_waitcnt vmcnt(7)
    s_add_u32 s33, s48, 81920
    s_add_u32 m0, s49, 16384
    s_nop 0
    buffer_load_dwordx4 v13, s[44:47], s33 offen nt lds
    s_waitcnt vmcnt(7)
    s_add_u32 s33, s48, 86016
    s_add_u32 m0, s49, 20480
    s_nop 0
    buffer_load_dwordx4 v13, s[44:47], s33 offen nt lds
    s_waitcnt vmcnt(7)
    s_add_u32 s33, s48, 90112
    s_add_u32 m0, s49, 24576
    s_nop 0
    buffer_load_dwordx4 v13, s[44:47], s33 offen nt lds
    s_waitcnt vmcnt(7)
    s_add_u32 s33, s48, 94208
    s_add_u32 m0, s49, 28672
    s_nop 0
    buffer_load_dwordx4 v13, s[44:47], s33 offen nt lds
    s_waitcnt vmcnt(7)
    s_add_u32 s33, s48, 98304
    s_add_u32 m0, s49, 0
    s_nop 0
    buffer_load_dwordx4 v13, s[44:47], s33 offen nt lds
    s_waitcnt vmcnt(7)
    s_add_u32 s33, s48, 102400
    s_add_u32 m0, s49, 4096
    s_nop 0
    buffer_load_dwordx4 v13, s[44:47], s33 offen nt lds
    s_waitcnt vmcnt(7)
    s_add_u32 s33, s48, 106496
    s_add_u32 m0, s49, 8192
    s_nop 0
    buffer_load_dwordx4 v13, s[44:47], s33 offen nt lds
    s_waitcnt vmcnt(7)
    s_add_u32 s33, s48, 110592
    s_add_u32 m0, s49, 12288
    s_nop 0
    buffer_load_dwordx4 v13, s[44:47], s33 offen nt lds
    s_waitcnt vmcnt(7)
    s_add_u32 s33, s48, 114688
    s_add_u32 m0, s49, 16384
    s_nop 0
    buffer_load_dwordx4 v13, s[44:47], s33 offen nt lds
    s_waitcnt vmcnt(7)
    s_add_u32 s33, s48, 118784
    s_add_u32 m0, s49, 20480
    s_nop 0
    buffer_load_dwordx4 v13, s[44:47], s33 offen nt lds
    s_waitcnt vmcnt(7)
    s_add_u32 s33, s48, 122880
    s_add_u32 m0, s49, 24576
    s_nop 0
    buffer_load_dwordx4 v13, s[44:47], s33 offen nt lds
    s_waitcnt vmcnt(7)
    s_add_u32 s33, s48, 126976
    s_add_u32 m0, s49, 28672
    s_nop 0
    buffer_load_dwordx4 v13, s[44:47], s33 offen nt lds
    s_waitcnt vmcnt(7)
    s_add_u32 s33, s48, 131072
    s_add_u32 m0, s49, 0
    s_nop 0
    buffer_load_dwordx4 v13, s[44:47], s33 offen nt lds
    s_waitcnt vmcnt(0) lgkmcnt(0)
    s_endpgm
L_kv_wo:
    s_add_u32 s33, s50, 0
    s_and_b32 s33, s33, 63
    s_lshl_b32 s33, s33, 10
    s_add_u32 m0, s49, 0
    s_nop 0
    buffer_load_dwordx4 v11, s[36:39], s33 offen nt lds
    s_waitcnt vmcnt(5)
    s_add_u32 s33, s50, 4
    s_and_b32 s33, s33, 63
    s_lshl_b32 s33, s33, 10
    s_add_u32 m0, s49, 4096
    s_nop 0
    buffer_load_dwordx4 v11, s[36:39], s33 offen nt lds
    s_waitcnt vmcnt(5)
    s_add_u32 s33, s50, 8
    s_and_b32 s33, s33, 63
    s_lshl_b32 s33, s33, 10
    s_add_u32 m0, s49, 8192
    s_nop 0
    buffer_load_dwordx4 v11, s[36:39], s33 offen nt lds
    s_waitcnt vmcnt(5)
    s_add_u32 s33, s50, 12
    s_and_b32 s33, s33, 63
    s_lshl_b32 s33, s33, 10
    s_add_u32 m0, s49, 12288
    s_nop 0
    buffer_load_dwordx4 v11, s[36:39], s33 offen nt lds
    s_waitcnt vmcnt(5)
    s_add_u32 s33, s50, 16
    s_and_b32 s33, s33, 63
    s_lshl_b32 s33, s33, 10
    s_add_u32 m0, s49, 16384
    s_nop 0
    buffer_load_dwordx4 v11, s[36:39], s33 offen nt lds
    s_waitcnt vmcnt(5)
    s_mov_b64 exec, 1
    ds_add_u32 v2, v3 offset:0
    s_mov_b64 exec, -1

    s_add_u32 s33, s50, 20
    s_and_b32 s33, s33, 63
    s_lshl_b32 s33, s33, 10
    s_add_u32 m0, s49, 20480
    s_nop 0
    buffer_load_dwordx4 v11, s[36:39], s33 offen nt lds
    s_waitcnt vmcnt(5)
    s_add_u32 s33, s50, 24
    s_and_b32 s33, s33, 63
    s_lshl_b32 s33, s33, 10
    s_add_u32 m0, s49, 24576
    s_nop 0
    buffer_load_dwordx4 v11, s[36:39], s33 offen nt lds
    s_waitcnt vmcnt(5)
    s_add_u32 s33, s50, 28
    s_and_b32 s33, s33, 63
    s_lshl_b32 s33, s33, 10
    s_add_u32 m0, s49, 28672
    s_nop 0
    buffer_load_dwordx4 v11, s[36:39], s33 offen nt lds
    s_waitcnt vmcnt(5)
    s_add_u32 s33, s50, 32
    s_and_b32 s33, s33, 63
    s_lshl_b32 s33, s33, 10
    s_add_u32 m0, s49, 32768
    s_nop 0
    buffer_load_dwordx4 v11, s[36:39], s33 offen nt lds
    s_waitcnt vmcnt(5)
    s_mov_b64 exec, 1
    ds_add_u32 v2, v3 offset:12
    s_mov_b64 exec, -1

    s_add_u32 s33, s50, 36
    s_and_b32 s33, s33, 63
    s_lshl_b32 s33, s33, 10
    s_add_u32 m0, s49, 36864
    s_nop 0
    buffer_load_dwordx4 v11, s[36:39], s33 offen nt lds
    s_waitcnt vmcnt(5)
    s_add_u32 s33, s50, 40
    s_and_b32 s33, s33, 63
    s_lshl_b32 s33, s33, 10
    s_add_u32 m0, s49, 40960
    s_nop 0
    buffer_load_dwordx4 v11, s[36:39], s33 offen nt lds
    s_waitcnt vmcnt(5)
    s_add_u32 s33, s50, 44
    s_and_b32 s33, s33, 63
    s_lshl_b32 s33, s33, 10
    s_add_u32 m0, s49, 45056
    s_nop 0
    buffer_load_dwordx4 v11, s[36:39], s33 offen nt lds
    s_waitcnt vmcnt(5)
    s_add_u32 s33, s50, 48
    s_and_b32 s33, s33, 63
    s_lshl_b32 s33, s33, 10
    s_add_u32 m0, s49, 49152
    s_nop 0
    buffer_load_dwordx4 v11, s[36:39], s33 offen nt lds
    s_waitcnt vmcnt(5)
    s_mov_b64 exec, 1
    ds_add_u32 v2, v3 offset:16
    s_mov_b64 exec, -1

    s_add_u32 s33, s50, 52
    s_and_b32 s33, s33, 63
    s_lshl_b32 s33, s33, 10
    s_add_u32 m0, s49, 53248
    s_nop 0
    buffer_load_dwordx4 v11, s[36:39], s33 offen nt lds
    s_waitcnt vmcnt(5)
    s_add_u32 s33, s50, 56
    s_and_b32 s33, s33, 63
    s_lshl_b32 s33, s33, 10
    s_add_u32 m0, s49, 57344
    s_nop 0
    buffer_load_dwordx4 v11, s[36:39], s33 offen nt lds
    s_waitcnt vmcnt(5)
    s_add_u32 s33, s50, 60
    s_and_b32 s33, s33, 63
    s_lshl_b32 s33, s33, 10
    s_add_u32 m0, s49, 61440
    s_nop 0
    buffer_load_dwordx4 v11, s[36:39], s33 offen nt lds
    s_waitcnt vmcnt(5)
    s_add_u32 s33, s50, 0
    s_and_b32 s33, s33, 63
    s_lshl_b32 s33, s33, 10
    s_add_u32 m0, s49, 65536
    s_nop 0
    buffer_load_dwordx4 v12, s[40:43], s33 offen nt lds
    s_waitcnt vmcnt(5)
    s_mov_b64 exec, 1
    ds_add_u32 v2, v3 offset:20
    s_mov_b64 exec, -1

    s_add_u32 s33, s50, 4
    s_and_b32 s33, s33, 63
    s_lshl_b32 s33, s33, 10
    s_add_u32 m0, s49, 69632
    s_nop 0
    buffer_load_dwordx4 v12, s[40:43], s33 offen nt lds
    s_waitcnt vmcnt(5)
    s_add_u32 s33, s50, 8
    s_and_b32 s33, s33, 63
    s_lshl_b32 s33, s33, 10
    s_add_u32 m0, s49, 73728
    s_nop 0
    buffer_load_dwordx4 v12, s[40:43], s33 offen nt lds
    s_waitcnt vmcnt(5)
    s_add_u32 s33, s50, 12
    s_and_b32 s33, s33, 63
    s_lshl_b32 s33, s33, 10
    s_add_u32 m0, s49, 77824
    s_nop 0
    buffer_load_dwordx4 v12, s[40:43], s33 offen nt lds
    s_waitcnt vmcnt(5)
    s_add_u32 s33, s50, 16
    s_and_b32 s33, s33, 63
    s_lshl_b32 s33, s33, 10
    s_add_u32 m0, s49, 81920
    s_nop 0
    buffer_load_dwordx4 v12, s[40:43], s33 offen nt lds
    s_waitcnt vmcnt(5)
    s_mov_b64 exec, 1
    ds_add_u32 v2, v3 offset:24
    s_mov_b64 exec, -1

    s_add_u32 s33, s50, 20
    s_and_b32 s33, s33, 63
    s_lshl_b32 s33, s33, 10
    s_add_u32 m0, s49, 86016
    s_nop 0
    buffer_load_dwordx4 v12, s[40:43], s33 offen nt lds
    s_waitcnt vmcnt(5)
    s_add_u32 s33, s50, 24
    s_and_b32 s33, s33, 63
    s_lshl_b32 s33, s33, 10
    s_add_u32 m0, s49, 90112
    s_nop 0
    buffer_load_dwordx4 v12, s[40:43], s33 offen nt lds
    s_waitcnt vmcnt(5)
    s_add_u32 s33, s50, 28
    s_and_b32 s33, s33, 63
    s_lshl_b32 s33, s33, 10
    s_add_u32 m0, s49, 94208
    s_nop 0
    buffer_load_dwordx4 v12, s[40:43], s33 offen nt lds
    s_waitcnt vmcnt(5)
    s_add_u32 s33, s50, 32
    s_and_b32 s33, s33, 63
    s_lshl_b32 s33, s33, 10
    s_add_u32 m0, s49, 98304
    s_nop 0
    buffer_load_dwordx4 v12, s[40:43], s33 offen nt lds
    s_waitcnt vmcnt(5)
    s_mov_b64 exec, 1
    ds_add_u32 v2, v3 offset:40
    s_mov_b64 exec, -1

    s_add_u32 s33, s50, 36
    s_and_b32 s33, s33, 63
    s_lshl_b32 s33, s33, 10
    s_add_u32 m0, s49, 102400
    s_nop 0
    buffer_load_dwordx4 v12, s[40:43], s33 offen nt lds
    s_waitcnt vmcnt(5)
    s_add_u32 s33, s50, 40
    s_and_b32 s33, s33, 63
    s_lshl_b32 s33, s33, 10
    s_add_u32 m0, s49, 106496
    s_nop 0
    buffer_load_dwordx4 v12, s[40:43], s33 offen nt lds
    s_waitcnt vmcnt(5)
    s_add_u32 s33, s50, 44
    s_and_b32 s33, s33, 63
    s_lshl_b32 s33, s33, 10
    s_add_u32 m0, s49, 110592
    s_nop 0
    buffer_load_dwordx4 v12, s[40:43], s33 offen nt lds
    s_waitcnt vmcnt(5)
    s_add_u32 s33, s50, 48
    s_and_b32 s33, s33, 63
    s_lshl_b32 s33, s33, 10
    s_add_u32 m0, s49, 114688
    s_nop 0
    buffer_load_dwordx4 v12, s[40:43], s33 offen nt lds
    s_waitcnt vmcnt(5)
    s_mov_b64 exec, 1
    ds_add_u32 v2, v3 offset:44
    s_mov_b64 exec, -1

    s_add_u32 s33, s50, 52
    s_and_b32 s33, s33, 63
    s_lshl_b32 s33, s33, 10
    s_add_u32 m0, s49, 118784
    s_nop 0
    buffer_load_dwordx4 v12, s[40:43], s33 offen nt lds
    s_waitcnt vmcnt(5)
    s_add_u32 s33, s50, 56
    s_and_b32 s33, s33, 63
    s_lshl_b32 s33, s33, 10
    s_add_u32 m0, s49, 122880
    s_nop 0
    buffer_load_dwordx4 v12, s[40:43], s33 offen nt lds
    s_waitcnt vmcnt(5)
    s_add_u32 s33, s50, 60
    s_and_b32 s33, s33, 63
    s_lshl_b32 s33, s33, 10
    s_add_u32 m0, s49, 126976
    s_nop 0
    buffer_load_dwordx4 v12, s[40:43], s33 offen nt lds
    s_mov_b32 s44, s12
    s_mov_b32 s45, s13
    s_mov_b32 s46, 4718592
    s_mov_b32 s47, 0x20000
    v_lshrrev_b32 v6, 3, v1
    v_mul_u32_u24 v7, 1152, v6
    v_add_u32 v14, v7, v8
    s_mul_i32 s48, s28, 589824
    s_sub_u32 s32, s34, 18
    s_lshl_b32 s32, s32, 7
    s_add_u32 s48, s48, s32
    s_mul_i32 s32, s30, 9216
    s_add_u32 s48, s48, s32
    s_mov_b32 s52, -2048
    s_cmp_lt_u32 s30, 2
    s_cselect_b32 s52, 147456, s52

Lsp_6:
    ds_read_b32 v4, v2 offset:4
    s_waitcnt lgkmcnt(0)
    v_readfirstlane_b32 s59, v4
    s_cmp_ge_u32 s59, 4
    s_cbranch_scc1 Lspx_7
    s_cmp_eq_u32 s57, 0
    s_cbranch_scc1 Lspx_7
    s_sub_u32 s57, s57, 1
    s_sleep 1
    s_branch Lsp_6
Lspx_7:

    s_waitcnt vmcnt(5)
    s_add_u32 s33, s48, 0
    s_add_u32 m0, s49, 131072
    s_nop 0
    buffer_load_dwordx4 v14, s[44:47], s33 offen nt lds
    s_waitcnt vmcnt(8)
    s_add_u32 s33, s48, 36864
    s_add_u32 m0, s49, 135168
    s_nop 0
    buffer_load_dwordx4 v14, s[44:47], s33 offen nt lds
    s_waitcnt vmcnt(8)
    s_add_u32 s33, s48, 73728
    s_add_u32 m0, s49, 139264
    s_nop 0
    buffer_load_dwordx4 v14, s[44:47], s33 offen nt lds
    s_waitcnt vmcnt(8)
    s_add_u32 s33, s48, 110592
    s_add_u32 m0, s49, 143360
    s_nop 0
    buffer_load_dwordx4 v14, s[44:47], s33 offen nt lds
Lsp_8:
    ds_read_b32 v4, v2 offset:32
    s_waitcnt lgkmcnt(0)
    v_readfirstlane_b32 s59, v4
    s_cmp_ge_u32 s59, 8
    s_cbranch_scc1 Lspx_9
    s_cmp_eq_u32 s57, 0
    s_cbranch_scc1 Lspx_9
    s_sub_u32 s57, s57, 1
    s_sleep 1
    s_branch Lsp_8
Lspx_9:

    s_waitcnt vmcnt(8)
    s_mov_b64 exec, 1
    ds_add_u32 v2, v3 offset:48
    s_mov_b64 exec, -1

    s_add_u32 s33, s48, 147456
    s_add_u32 m0, s49, s52
    s_nop 0
    buffer_load_dwordx4 v14, s[44:47], s33 offen nt lds
    s_waitcnt vmcnt(8)
    s_add_u32 s33, s48, 184320
    s_add_u32 m0, s49, 2048
    s_nop 0
    buffer_load_dwordx4 v14, s[44:47], s33 offen nt lds
    s_waitcnt vmcnt(8)
    s_add_u32 s33, s48, 221184
    s_add_u32 m0, s49, 6144
    s_nop 0
    buffer_load_dwordx4 v14, s[44:47], s33 offen nt lds
    s_waitcnt vmcnt(8)
    s_add_u32 s33, s48, 258048
    s_add_u32 m0, s49, 10240
    s_nop 0
    buffer_load_dwordx4 v14, s[44:47], s33 offen nt lds
    s_waitcnt vmcnt(8)
    s_mov_b64 exec, 1
    ds_add_u32 v2, v3 offset:52
    s_mov_b64 exec, -1

    s_add_u32 s33, s48, 294912
    s_add_u32 m0, s49, 14336
    s_nop 0
    buffer_load_dwordx4 v14, s[44:47], s33 offen nt lds
    s_waitcnt vmcnt(8)
    s_add_u32 s33, s48, 331776
    s_add_u32 m0, s49, 18432
    s_nop 0
    buffer_load_dwordx4 v14, s[44:47], s33 offen nt lds
    s_waitcnt vmcnt(8)
    s_add_u32 s33, s48, 368640
    s_add_u32 m0, s49, 22528
    s_nop 0
    buffer_load_dwordx4 v14, s[44:47], s33 offen nt lds
    s_waitcnt vmcnt(8)
    s_add_u32 s33, s48, 405504
    s_add_u32 m0, s49, 26624
    s_nop 0
    buffer_load_dwordx4 v14, s[44:47], s33 offen nt lds
    s_waitcnt vmcnt(8)
    s_add_u32 s33, s48, 442368
    s_add_u32 m0, s49, 30720
    s_nop 0
    buffer_load_dwordx4 v14, s[44:47], s33 offen nt lds
    s_waitcnt vmcnt(8)
    s_add_u32 s33, s48, 479232
    s_add_u32 m0, s49, 34816
    s_nop 0
    buffer_load_dwordx4 v14, s[44:47], s33 offen nt lds
    s_waitcnt vmcnt(8)
    s_add_u32 s33, s48, 516096
    s_add_u32 m0, s49, 38912
    s_nop 0
    buffer_load_dwordx4 v14, s[44:47], s33 offen nt lds
    s_waitcnt vmcnt(8)
    s_add_u32 s33, s48, 552960
    s_add_u32 m0, s49, 43008
    s_nop 0
    buffer_load_dwordx4 v14, s[44:47], s33 offen nt lds
    s_waitcnt vmcnt(0)
    s_mov_b64 exec, 1
    ds_add_u32 v2, v3 offset:56
    s_mov_b64 exec, -1

    s_waitcnt vmcnt(0) lgkmcnt(0)
    s_endpgm
L_ld_ffn:
    s_bitcmp1_b32 s34, 0
    s_cselect_b32 s44, s18, s16
    s_cselect_b32 s45, s19, s17
    s_mov_b32 s46, 5308416
    s_mov_b32 s47, 0x20000
    v_lshrrev_b32 v6, 3, v1
    v_mul_u32_u24 v7, 9216, v6
    v_add_u32 v14, v7, v8
    v_mul_u32_u24 v7, 1152, v6
    v_add_u32 v15, v7, v8
    s_lshr_b32 s32, s34, 1
    s_mul_i32 s51, s28, 9
    s_add_u32 s32, s32, s51
    s_lshl_b32 s48, s32, 7
    s_mul_i32 s32, s30, 73728
    s_add_u32 s48, s48, s32
    s_mov_b32 s53, -2048
    s_cmp_lt_u32 s30, 2
    s_cselect_b32 s53, 147456, s53
    s_mul_i32 s51, s28, 18
    s_add_u32 s51, s51, s34
    s_mul_i32 s52, s51, 36864
    s_mul_i32 s32, s30, 9216
    s_add_u32 s52, s52, s32

    s_mov_b32 s36, s20
    s_mov_b32 s37, s21
    s_mov_b32 s38, 5308416
    s_mov_b32 s39, 0x20000
Lsp_10:
    ds_read_b32 v4, v2 offset:4
    s_waitcnt lgkmcnt(0)
    v_readfirstlane_b32 s59, v4
    s_cmp_ge_u32 s59, 4
    s_cbranch_scc1 Lspx_11
    s_cmp_eq_u32 s57, 0
    s_cbranch_scc1 Lspx_11
    s_sub_u32 s57, s57, 1
    s_sleep 1
    s_branch Lsp_10
Lspx_11:

    s_waitcnt vmcnt(4)
    s_mov_b64 exec, 1
    ds_add_u32 v2, v3 offset:48
    s_mov_b64 exec, -1

    s_waitcnt vmcnt(2)
    s_add_u32 s33, s48, 0
    s_add_u32 m0, s49, 131072
    s_nop 0
    buffer_load_dwordx4 v14, s[44:47], s33 offen nt lds
    s_waitcnt vmcnt(2)
    s_add_u32 s33, s48, 294912
    s_add_u32 m0, s49, 135168
    s_nop 0
    buffer_load_dwordx4 v14, s[44:47], s33 offen nt lds
    s_waitcnt vmcnt(2)
    s_mov_b64 exec, 1
    ds_add_u32 v2, v3 offset:52
    s_mov_b64 exec, -1

    s_add_u32 s33, s48, 589824
    s_add_u32 m0, s49, 139264
    s_nop 0
    buffer_load_dwordx4 v14, s[44:47], s33 offen nt lds
    s_waitcnt vmcnt(2)
    s_add_u32 s33, s48, 884736
    s_add_u32 m0, s49, 143360
    s_nop 0
    buffer_load_dwordx4 v14, s[44:47], s33 offen nt lds
Lsp_12:
    ds_read_b32 v4, v2 offset:32
    s_waitcnt lgkmcnt(0)
    v_readfirstlane_b32 s59, v4
    s_cmp_ge_u32 s59, 8
    s_cbranch_scc1 Lspx_13
    s_cmp_eq_u32 s57, 0
    s_cbranch_scc1 Lspx_13
    s_sub_u32 s57, s57, 1
    s_sleep 1
    s_branch Lsp_12
Lspx_13:

    s_waitcnt vmcnt(2)
    s_add_u32 s33, s48, 1179648
    s_add_u32 m0, s49, s53
    s_nop 0
    buffer_load_dwordx4 v14, s[44:47], s33 offen nt lds
    s_waitcnt vmcnt(2)
    s_add_u32 s33, s48, 1474560
    s_add_u32 m0, s49, 2048
    s_nop 0
    buffer_load_dwordx4 v14, s[44:47], s33 offen nt lds
    s_waitcnt vmcnt(2)
    s_add_u32 s33, s48, 1769472
    s_add_u32 m0, s49, 6144
    s_nop 0
    buffer_load_dwordx4 v14, s[44:47], s33 offen nt lds
    s_waitcnt vmcnt(7)
    s_add_u32 s33, s48, 2064384
    s_add_u32 m0, s49, 10240
    s_nop 0
    buffer_load_dwordx4 v14, s[44:47], s33 offen nt lds
    s_waitcnt vmcnt(7)
    s_add_u32 s33, s48, 2359296
    s_add_u32 m0, s49, 14336
    s_nop 0
    buffer_load_dwordx4 v14, s[44:47], s33 offen nt lds
    s_waitcnt vmcnt(7)
    s_add_u32 s33, s48, 2654208
    s_add_u32 m0, s49, 18432
    s_nop 0
    buffer_load_dwordx4 v14, s[44:47], s33 offen nt lds
    s_waitcnt vmcnt(7)
    s_add_u32 s33, s48, 2949120
    s_add_u32 m0, s49, 22528
    s_nop 0
    buffer_load_dwordx4 v14, s[44:47], s33 offen nt lds
    s_waitcnt vmcnt(7)
    s_add_u32 s33, s48, 3244032
    s_add_u32 m0, s49, 26624
    s_nop 0
    buffer_load_dwordx4 v14, s[44:47], s33 offen nt lds
    s_waitcnt vmcnt(7)
    s_add_u32 s33, s48, 3538944
    s_add_u32 m0, s49, 30720
    s_nop 0
    buffer_load_dwordx4 v14, s[44:47], s33 offen nt lds
    s_waitcnt vmcnt(7)
    s_add_u32 s33, s48, 3833856
    s_add_u32 m0, s49, 34816
    s_nop 0
    buffer_load_dwordx4 v14, s[44:47], s33 offen nt lds
    s_waitcnt vmcnt(7)
    s_add_u32 s33, s48, 4128768
    s_add_u32 m0, s49, 38912
    s_nop 0
    buffer_load_dwordx4 v14, s[44:47], s33 offen nt lds
    s_waitcnt vmcnt(7)
    s_mov_b64 exec, 1
    ds_add_u32 v2, v3 offset:64
    s_mov_b64 exec, -1

    s_add_u32 s33, s48, 4423680
    s_add_u32 m0, s49, 43008
    s_nop 0
    buffer_load_dwordx4 v14, s[44:47], s33 offen nt lds
    s_waitcnt vmcnt(7)
    s_add_u32 s33, s48, 4718592
    s_add_u32 m0, s49, 47104
    s_nop 0
    buffer_load_dwordx4 v14, s[44:47], s33 offen nt lds
    s_waitcnt vmcnt(7)
    s_add_u32 s33, s48, 5013504
    s_add_u32 m0, s49, 51200
    s_nop 0
    buffer_load_dwordx4 v14, s[44:47], s33 offen nt lds
Lsp_14:
    ds_read_b32 v4, v2 offset:60
    s_waitcnt lgkmcnt(0)
    v_readfirstlane_b32 s59, v4
    s_cmp_ge_u32 s59, 8
    s_cbranch_scc1 Lspx_15
    s_cmp_eq_u32 s57, 0
    s_cbranch_scc1 Lspx_15
    s_sub_u32 s57, s57, 1
    s_sleep 1
    s_branch Lsp_14
Lspx_15:

    s_waitcnt vmcnt(7)
    s_add_u32 s33, s52, 0
    s_add_u32 m0, s49, 65536
    s_nop 0
    buffer_load_dwordx4 v15, s[36:39], s33 offen nt lds
    s_waitcnt vmcnt(7)
    s_add_u32 s33, s52, 128
    s_add_u32 m0, s49, 69632
    s_nop 0
    buffer_load_dwordx4 v15, s[36:39], s33 offen nt lds
    s_waitcnt vmcnt(7)
    s_add_u32 s33, s52, 256
    s_add_u32 m0, s49, 73728
    s_nop 0
    buffer_load_dwordx4 v15, s[36:39], s33 offen nt lds
    s_waitcnt vmcnt(7)
    s_mov_b64 exec, 1
    ds_add_u32 v2, v3 offset:68
    s_mov_b64 exec, -1

    s_add_u32 s33, s52, 384
    s_add_u32 m0, s49, 77824
    s_nop 0
    buffer_load_dwordx4 v15, s[36:39], s33 offen nt lds
    s_waitcnt vmcnt(7)
    s_add_u32 s33, s52, 512
    s_add_u32 m0, s49, 81920
    s_nop 0
    buffer_load_dwordx4 v15, s[36:39], s33 offen nt lds
    s_waitcnt vmcnt(7)
    s_add_u32 s33, s52, 640
    s_add_u32 m0, s49, 86016
    s_nop 0
    buffer_load_dwordx4 v15, s[36:39], s33 offen nt lds
    s_waitcnt vmcnt(7)
    s_add_u32 s33, s52, 768
    s_add_u32 m0, s49, 90112
    s_nop 0
    buffer_load_dwordx4 v15, s[36:39], s33 offen nt lds
    s_waitcnt vmcnt(7)
    s_mov_b64 exec, 1
    ds_add_u32 v2, v3 offset:72
    s_mov_b64 exec, -1

    s_add_u32 s33, s52, 896
    s_add_u32 m0, s49, 94208
    s_nop 0
    buffer_load_dwordx4 v15, s[36:39], s33 offen nt lds
    s_waitcnt vmcnt(7)
    s_add_u32 s33, s52, 1024
    s_add_u32 m0, s49, 98304
    s_nop 0
    buffer_load_dwordx4 v15, s[36:39], s33 offen nt lds
    s_waitcnt vmcnt(0)
    s_mov_b64 exec, 1
    ds_add_u32 v2, v3 offset:76
    s_mov_b64 exec, -1

    s_waitcnt vmcnt(0) lgkmcnt(0)
    s_endpgm
L_compute:
    s_setprio 3

    s_sub_u32 s31, s30, 4
    v_lshlrev_b32 v10, 4, v1
    v_mov_b32 v11, 0

    s_mov_b32 s36, s4
    s_mov_b32 s37, s5
    s_mov_b32 s38, 1152
    s_mov_b32 s39, 0x20000
    global_load_dword v24, v11, s[26:27] sc1
    s_cmp_ge_u32 s31, 4
    s_cbranch_scc1 L_nox
    buffer_load_dwordx4 v[16:19], v10, s[36:39], 0 offen
    buffer_load_dwordx4 v[20:23], v10, s[36:39], 0 offen offset:1024
L_nox:
    s_barrier

    s_cmp_eq_u32 s31, 0
    s_cbranch_scc0 L_noqt
    s_lshl_b32 s32, s28, 7
    s_add_u32 s32, s32, 2048
    v_mov_b32 v145, s32
    global_load_dword v147, v145, s[26:27] sc1
    s_lshl_b32 s32, s29, 12
    s_lshr_b32 s33, s35, 2
    s_lshl_b32 s33, s33, 10
    s_add_u32 s32, s32, s33
    s_and_b32 s33, s35, 3
    s_lshl_b32 s33, s33, 8
    s_add_u32 s32, s32, s33
    s_add_u32 s48, s26, s32
    s_addc_u32 s49, s27, 0
    s_add_u32 s48, s48, 1052672
    s_addc_u32 s49, s49, 0
    v_lshlrev_b32 v144, 2, v1
    global_load_dword v144, v144, s[48:49] sc1
L_noqt:
    v_mov_b32 v5, 0xff
    v_lshrrev_b32 v6, 4, v1
    v_and_b32 v7, 15, v1
    v_lshrrev_b32 v8, 2, v7
    v_and_b32 v9, 3, v1
    v_lshlrev_b32 v29, 4, v6
    s_mov_b32 s40, 0x00010001
    s_mov_b32 s41, 0x00010001
    s_mov_b32 s42, 0x00030003
    s_mov_b32 s43, 0x00030003
    s_mov_b32 s44, 0xff
    s_mov_b32 s45, 0
    s_mov_b32 s46, 0xffff
    s_mov_b32 s47, 0
    v_lshl_add_u32 v13, v6, 2, v8
    v_lshrrev_b32 v14, 1, v13
    v_and_b32 v14, 3, v14
    v_lshlrev_b32 v14, 1, v14
    v_lshrrev_b32 v15, 1, v9
    s_and_b32 s32, s31, 3
    s_lshl_b32 s32, s32, 1
    v_add_u32 v25, s32, v15
    v_xor_b32 v25, v25, v14
    v_lshlrev_b32 v25, 4, v25
    v_lshl_add_u32 v25, v13, 7, v25
    v_and_b32 v26, 1, v9
    v_lshl_add_u32 v25, v26, 3, v25
    s_cmp_eq_u32 s31, 0
    s_cbranch_scc1 L_w4
    s_waitcnt vmcnt(0)
L_w4:
    s_waitcnt vmcnt(2)
    v_readfirstlane_b32 s32, v24
    s_mul_i32 s32, s32, 1664525
    s_add_u32 s32, s32, 1013904223
    s_or_b32 s51, s32, 0x01010101
    s_and_b32 s52, s51, 0xff
    s_bfe_u32 s53, s51, 0x80008
    s_bfe_u32 s54, s51, 0x80010
    s_lshr_b32 s55, s51, 24
    s_getreg_b32 s32, hwreg(HW_REG_XCC_ID, 0, 3)
    s_and_b32 s56, s51, 0xfffffff8
    s_or_b32 s56, s56, s32
    s_mov_b32 s20, 0
    s_cmp_eq_u32 s31, 0
    s_cbranch_scc0 L_nocen
    s_lshl_b32 s32, s28, 7
    s_lshl_b32 s33, s34, 2
    s_add_u32 s32, s32, s33
    s_add_u32 s32, s32, 2048
    v_mov_b32 v143, s32
    v_mov_b32 v146, s56
    s_mov_b64 exec, 1
    global_store_dword v143, v146, s[26:27]
    s_mov_b64 exec, -1
L_nocen:

    s_cmp_ge_u32 s31, 4
    s_cbranch_scc1 L_qwait
    v_lshlrev_b32 v32, 16, v16
    v_and_b32 v33, 0xffff0000, v16
    v_lshlrev_b32 v34, 16, v17
    v_and_b32 v35, 0xffff0000, v17
    v_lshlrev_b32 v36, 16, v18
    v_and_b32 v37, 0xffff0000, v18
    v_lshlrev_b32 v38, 16, v19
    v_and_b32 v39, 0xffff0000, v19
    v_lshlrev_b32 v40, 16, v20
    v_and_b32 v41, 0xffff0000, v20
    v_lshlrev_b32 v42, 16, v21
    v_and_b32 v43, 0xffff0000, v21
    v_lshlrev_b32 v44, 16, v22
    v_and_b32 v45, 0xffff0000, v22
    v_lshlrev_b32 v46, 16, v23
    v_and_b32 v47, 0xffff0000, v23
    v_pk_mul_f32 v[50:51], v[32:33], v[32:33]
    v_mov_b32 v48, v32
    v_mov_b32 v49, v33
    v_pk_fma_f32 v[50:51], v[34:35], v[34:35], v[50:51]
    v_pk_add_f32 v[48:49], v[48:49], v[34:35]
    v_pk_fma_f32 v[50:51], v[36:37], v[36:37], v[50:51]
    v_pk_add_f32 v[48:49], v[48:49], v[36:37]
    v_pk_fma_f32 v[50:51], v[38:39], v[38:39], v[50:51]
    v_pk_add_f32 v[48:49], v[48:49], v[38:39]
    v_pk_fma_f32 v[50:51], v[40:41], v[40:41], v[50:51]
    v_pk_add_f32 v[48:49], v[48:49], v[40:41]
    v_pk_fma_f32 v[50:51], v[42:43], v[42:43], v[50:51]
    v_pk_add_f32 v[48:49], v[48:49], v[42:43]
    v_pk_fma_f32 v[50:51], v[44:45], v[44:45], v[50:51]
    v_pk_add_f32 v[48:49], v[48:49], v[44:45]
    v_pk_fma_f32 v[50:51], v[46:47], v[46:47], v[50:51]
    v_pk_add_f32 v[48:49], v[48:49], v[46:47]
    v_add_f32 v48, v48, v49
    v_add_f32 v50, v50, v51
    s_nop 0
    v_add_f32_dpp v48, v48, v48 row_ror:8 row_mask:0xf bank_mask:0xf
    v_add_f32_dpp v50, v50, v50 row_ror:8 row_mask:0xf bank_mask:0xf
    s_nop 0
    v_add_f32_dpp v48, v48, v48 row_ror:4 row_mask:0xf bank_mask:0xf
    v_add_f32_dpp v50, v50, v50 row_ror:4 row_mask:0xf bank_mask:0xf
    s_nop 0
    v_add_f32_dpp v48, v48, v48 row_ror:2 row_mask:0xf bank_mask:0xf
    v_add_f32_dpp v50, v50, v50 row_ror:2 row_mask:0xf bank_mask:0xf
    s_nop 0
    v_add_f32_dpp v48, v48, v48 row_ror:1 row_mask:0xf bank_mask:0xf
    v_add_f32_dpp v50, v50, v50 row_ror:1 row_mask:0xf bank_mask:0xf
    v_mov_b32 v49, v48
    v_mov_b32 v51, v50
    s_nop 1
    v_permlane16_swap_b32 v49, v48
    v_permlane16_swap_b32 v51, v50
    s_nop 0
    v_add_f32 v48, v48, v49
    v_add_f32 v50, v50, v51
    v_mov_b32 v49, v48
    v_mov_b32 v51, v50
    s_nop 1
    v_permlane32_swap_b32 v49, v48
    v_permlane32_swap_b32 v51, v50
    s_nop 0
    v_add_f32 v48, v48, v49
    v_add_f32 v50, v50, v51
    v_mul_f32 v48, 0x3ae38e39, v48
    v_mul_f32 v50, 0x3ae38e39, v50
    v_fma_f32 v50, -v48, v48, v50
    v_max_f32 v50, 0, v50
    v_cvt_pk_bf16_f32 v49, v48, v50
    v_lshlrev_b32 v48, 16, v49
    v_and_b32 v50, 0xffff0000, v49
    v_add_f32 v50, 0x3727c5ac, v50
    v_cvt_pk_bf16_f32 v49, v50, v50
    v_and_b32 v50, 0xffff0000, v49
    v_sqrt_f32 v50, v50
    s_nop 0
    v_cvt_pk_bf16_f32 v49, v50, v50
    v_and_b32 v50, 0xffff0000, v49
    v_rcp_f32 v50, v50
    s_nop 0

    v_sub_f32 v32, v32, v48
    v_sub_f32 v33, v33, v48
    v_cvt_pk_bf16_f32 v49, v32, v33
    v_lshlrev_b32 v32, 16, v49
    v_and_b32 v33, 0xffff0000, v49
    v_mul_f32 v32, v32, v50
    v_mul_f32 v33, v33, v50
    v_cvt_pk_bf16_f32 v16, v32, v33
    v_sub_f32 v34, v34, v48
    v_sub_f32 v35, v35, v48
    v_cvt_pk_bf16_f32 v49, v34, v35
    v_lshlrev_b32 v34, 16, v49
    v_and_b32 v35, 0xffff0000, v49
    v_mul_f32 v34, v34, v50
    v_mul_f32 v35, v35, v50
    v_cvt_pk_bf16_f32 v17, v34, v35
    v_sub_f32 v36, v36, v48
    v_sub_f32 v37, v37, v48
    v_cvt_pk_bf16_f32 v49, v36, v37
    v_lshlrev_b32 v36, 16, v49
    v_and_b32 v37, 0xffff0000, v49
    v_mul_f32 v36, v36, v50
    v_mul_f32 v37, v37, v50
    v_cvt_pk_bf16_f32 v18, v36, v37
    v_sub_f32 v38, v38, v48
    v_sub_f32 v39, v39, v48
    v_cvt_pk_bf16_f32 v49, v38, v39
    v_lshlrev_b32 v38, 16, v49
    v_and_b32 v39, 0xffff0000, v49
    v_mul_f32 v38, v38, v50
    v_mul_f32 v39, v39, v50
    v_cvt_pk_bf16_f32 v19, v38, v39
    v_sub_f32 v40, v40, v48
    v_sub_f32 v41, v41, v48
    v_cvt_pk_bf16_f32 v49, v40, v41
    v_lshlrev_b32 v40, 16, v49
    v_and_b32 v41, 0xffff0000, v49
    v_mul_f32 v40, v40, v50
    v_mul_f32 v41, v41, v50
    v_cvt_pk_bf16_f32 v20, v40, v41
    v_sub_f32 v42, v42, v48
    v_sub_f32 v43, v43, v48
    v_cvt_pk_bf16_f32 v49, v42, v43
    v_lshlrev_b32 v42, 16, v49
    v_and_b32 v43, 0xffff0000, v49
    v_mul_f32 v42, v42, v50
    v_mul_f32 v43, v43, v50
    v_cvt_pk_bf16_f32 v21, v42, v43
    v_sub_f32 v44, v44, v48
    v_sub_f32 v45, v45, v48
    v_cvt_pk_bf16_f32 v49, v44, v45
    v_lshlrev_b32 v44, 16, v49
    v_and_b32 v45, 0xffff0000, v49
    v_mul_f32 v44, v44, v50
    v_mul_f32 v45, v45, v50
    v_cvt_pk_bf16_f32 v22, v44, v45
    v_sub_f32 v46, v46, v48
    v_sub_f32 v47, v47, v48
    v_cvt_pk_bf16_f32 v49, v46, v47
    v_lshlrev_b32 v46, 16, v49
    v_and_b32 v47, 0xffff0000, v49
    v_mul_f32 v46, v46, v50
    v_mul_f32 v47, v47, v50
    v_cvt_pk_bf16_f32 v23, v46, v47
    v_add_u32 v12, 149504, v10
    ds_write_b128 v12, v[16:19]
    s_mov_b64 exec, s[44:45]
    ds_write_b128 v12, v[20:23] offset:1024
    s_mov_b64 exec, -1
    v_add_u32 v27, 131072, v25
    s_lshr_b32 s32, s35, 2
    s_mul_i32 s32, s32, 288
    s_add_u32 s32, s32, 149504
    v_lshlrev_b32 v28, 3, v6
    v_add_u32 v28, s32, v28
    s_lshl_b32 s32, s29, 12
    s_lshr_b32 s33, s35, 2
    s_lshl_b32 s33, s33, 10
    s_add_u32 s32, s32, s33
    s_and_b32 s33, s35, 3
    s_lshl_b32 s33, s33, 8
    s_add_u32 s32, s32, s33
    s_lshl_b32 s33, s31, 6
    s_add_u32 s32, s32, s33

    s_add_u32 s48, s26, s32
    s_addc_u32 s49, s27, 0
    s_add_u32 s48, s48, 4096
    s_addc_u32 s49, s49, 0
    s_add_u32 s50, s48, 1048576
    s_addc_u32 s51, s49, 0
    s_waitcnt lgkmcnt(0)
Lsp_16:
    ds_read_b32 v4, v2 offset:0
    s_waitcnt lgkmcnt(0)
    v_readfirstlane_b32 s59, v4
    s_cmp_ge_u32 s59, 4
    s_cbranch_scc1 Lspx_17
    s_cmp_eq_u32 s57, 0
    s_cbranch_scc1 Lspx_17
    s_sub_u32 s57, s57, 1

    s_branch Lsp_16
Lspx_17:

    ds_read_b64_tr_b16 v[32:33], v27 offset:0
    ds_read_b64 v[52:53], v28 offset:0
    ds_read_b64_tr_b16 v[34:35], v27 offset:2048
    ds_read_b64 v[54:55], v28 offset:32
    ds_read_b64_tr_b16 v[36:37], v27 offset:4096
    ds_read_b64 v[56:57], v28 offset:64
    ds_read_b64_tr_b16 v[38:39], v27 offset:6144
    ds_read_b64 v[58:59], v28 offset:96
    ds_read_b64_tr_b16 v[40:41], v27 offset:8192
    ds_read_b64 v[60:61], v28 offset:128
    ds_read_b64_tr_b16 v[42:43], v27 offset:10240
    ds_read_b64 v[62:63], v28 offset:160
    ds_read_b64_tr_b16 v[44:45], v27 offset:12288
    ds_read_b64 v[64:65], v28 offset:192
    ds_read_b64_tr_b16 v[46:47], v27 offset:14336
    ds_read_b64 v[66:67], v28 offset:224
    ds_read_b64_tr_b16 v[48:49], v27 offset:16384
    ds_read_b64 v[68:69], v28 offset:256
    s_waitcnt lgkmcnt(0)
    s_mov_b64 exec, 1
    ds_add_u32 v2, v3 offset:4
    s_mov_b64 exec, -1

    v_mfma_f32_16x16x16_bf16 v[72:75], v[32:33], v[52:53], 0
    v_mfma_f32_16x16x16_bf16 v[72:75], v[34:35], v[54:55], v[72:75]
    v_mfma_f32_16x16x16_bf16 v[72:75], v[36:37], v[56:57], v[72:75]
    v_mfma_f32_16x16x16_bf16 v[72:75], v[38:39], v[58:59], v[72:75]
    v_mfma_f32_16x16x16_bf16 v[72:75], v[40:41], v[60:61], v[72:75]
    v_mfma_f32_16x16x16_bf16 v[72:75], v[42:43], v[62:63], v[72:75]
    v_mfma_f32_16x16x16_bf16 v[72:75], v[44:45], v[64:65], v[72:75]
    v_mfma_f32_16x16x16_bf16 v[72:75], v[46:47], v[66:67], v[72:75]
    v_mfma_f32_16x16x16_bf16 v[72:75], v[48:49], v[68:69], v[72:75]
    s_nop 7
    v_bfi_b32 v72, v5, s52, v72
    v_bfi_b32 v73, v5, s53, v73
    v_bfi_b32 v74, v5, s54, v74
    v_bfi_b32 v75, v5, s55, v75
    s_mov_b64 exec, s[40:41]
    global_store_dwordx4 v29, v[72:75], s[50:51]
    global_store_dwordx4 v29, v[72:75], s[48:49] sc1
    s_mov_b64 exec, -1
    s_cmp_eq_u32 s31, 0
    s_cbranch_scc0 L_qwait
    s_lshl_b32 s32, s29, 12
    s_add_u32 s48, s26, s32
    s_addc_u32 s49, s27, 0
    s_add_u32 s48, s48, 1052672
    s_addc_u32 s49, s49, 0
    s_lshl_b32 s59, s28, 7
    s_add_u32 s59, s59, 2048
    v_and_b32 v50, 31, v1
    v_lshl_add_u32 v50, v50, 2, s59

    s_mov_b32 s4, 64
    s_mov_b32 s5, -1048576
Lpl_18:
    global_load_dwordx4 v[32:35], v10, s[48:49] offset:0 sc1
    global_load_dwordx4 v[36:39], v10, s[48:49] offset:1024 sc1
    global_load_dwordx4 v[40:43], v10, s[48:49] offset:2048 sc1
    global_load_dwordx4 v[44:47], v10, s[48:49] offset:3072 sc1
    global_load_dword v51, v50, s[26:27] sc1
    s_waitcnt vmcnt(0)
    v_xor_b32 v32, s52, v32
    v_xor_b32 v33, s53, v33
    v_xor_b32 v34, s54, v34
    v_xor_b32 v35, s55, v35
    v_or3_b32 v30, v32, v33, v34
    v_or_b32 v30, v30, v35
    v_xor_b32 v36, s52, v36
    v_xor_b32 v37, s53, v37
    v_xor_b32 v38, s54, v38
    v_xor_b32 v39, s55, v39
    v_or3_b32 v30, v30, v36, v37
    v_or3_b32 v30, v30, v38, v39
    v_xor_b32 v40, s52, v40
    v_xor_b32 v41, s53, v41
    v_xor_b32 v42, s54, v42
    v_xor_b32 v43, s55, v43
    v_or3_b32 v30, v30, v40, v41
    v_or3_b32 v30, v30, v42, v43
    v_xor_b32 v44, s52, v44
    v_xor_b32 v45, s53, v45
    v_xor_b32 v46, s54, v46
    v_xor_b32 v47, s55, v47
    v_or3_b32 v30, v30, v44, v45
    v_or3_b32 v30, v30, v46, v47
    v_and_b32 v30, 0xff, v30
    v_cmp_ne_u32 vcc, 0, v30
    s_cbranch_vccz Lplx_19
    s_cmp_eq_u32 s58, 0
    s_cbranch_scc1 Lplx_19
    s_sub_u32 s58, s58, 1

    s_cmp_eq_u32 s4, 0
    s_cbranch_scc1 Lplt_21
    s_sub_u32 s4, s4, 1
    s_branch Lpl_18
Lplt_21:

    s_ashr_i32 s6, s5, 31
    s_add_u32 s48, s48, s5
    s_addc_u32 s49, s49, s6
    s_sub_u32 s5, 0, s5
    s_branch Lpl_18
Lplx_19:
    v_cmp_ne_u32 vcc, s56, v51
    s_cmp_eq_u64 vcc, 0
    s_cselect_b32 s20, 1, 0
    v_mov_b32 v50, s20
    s_mov_b64 exec, 1
    ds_write_b32 v2, v50 offset:88
    s_mov_b64 exec, -1

    v_add_f32 v32, v32, v36
    v_add_f32 v40, v40, v44
    v_add_f32 v32, v32, v40
    v_add_f32 v33, v33, v37
    v_add_f32 v41, v41, v45
    v_add_f32 v33, v33, v41
    v_add_f32 v34, v34, v38
    v_add_f32 v42, v42, v46
    v_add_f32 v34, v34, v42
    v_add_f32 v35, v35, v39
    v_add_f32 v43, v43, v47
    v_add_f32 v35, v35, v43
    v_cvt_pk_bf16_f32 v32, v32, v33
    v_cvt_pk_bf16_f32 v33, v34, v35
    v_lshlrev_b32 v30, 3, v1
    v_add_u32 v30, 150784, v30
    ds_write_b64 v30, v[32:33]
    s_waitcnt lgkmcnt(0)

    s_mov_b64 exec, 1
    ds_add_u32 v2, v3 offset:8
    s_mov_b64 exec, -1

L_qwait:
    s_lshl_b32 s32, s31, 13
    v_lshlrev_b32 v31, 8, v7
    v_add_u32 v31, s32, v31

    v_add_u32 v48, 0, v6
    v_xor_b32 v48, v48, v7
    v_lshl_add_u32 v48, v48, 4, v31
    v_add_u32 v49, 4, v6
    v_xor_b32 v49, v49, v7
    v_lshl_add_u32 v49, v49, 4, v31
    v_add_u32 v50, 8, v6
    v_xor_b32 v50, v50, v7
    v_lshl_add_u32 v50, v50, 4, v31
    v_add_u32 v51, 12, v6
    v_xor_b32 v51, v51, v7
    v_lshl_add_u32 v51, v51, 4, v31
    v_and_b32 v30, 1, v7
    v_lshlrev_b32 v30, 8, v30
    v_lshl_add_u32 v30, v6, 4, v30
    v_add_u32 v30, 150784, v30
    s_lshr_b32 s32, s31, 1
    s_lshl_b32 s32, s32, 2
    s_add_u32 s32, s32, 152396
    v_mov_b32 v52, s32

Lsp_22:
    ds_read_b32 v4, v2 offset:8
    s_waitcnt lgkmcnt(0)
    v_readfirstlane_b32 s59, v4
    s_cmp_ge_u32 s59, 1
    s_cbranch_scc1 Lspx_23
    s_cmp_eq_u32 s57, 0
    s_cbranch_scc1 Lspx_23
    s_sub_u32 s57, s57, 1
    s_sleep 1
    s_branch Lsp_22
Lspx_23:

    ds_read_b128 v[32:35], v30 offset:0
    ds_read_b128 v[36:39], v30 offset:64
    ds_read_b128 v[40:43], v30 offset:128
    ds_read_b128 v[44:47], v30 offset:192
Lsp_24:
    ds_read_b32 v4, v52
    s_waitcnt lgkmcnt(0)
    v_readfirstlane_b32 s59, v4
    s_cmp_ge_u32 s59, 4
    s_cbranch_scc1 Lspx_25
    s_cmp_eq_u32 s57, 0
    s_cbranch_scc1 Lspx_25
    s_sub_u32 s57, s57, 1

    s_branch Lsp_24
Lspx_25:

    ds_read_b128 v[64:67], v48 offset:0
    ds_read_b128 v[68:71], v49 offset:0
    ds_read_b128 v[72:75], v50 offset:0
    ds_read_b128 v[76:79], v51 offset:0
    ds_read_b128 v[80:83], v48 offset:4096
    ds_read_b128 v[84:87], v49 offset:4096
    ds_read_b128 v[88:91], v50 offset:4096
    ds_read_b128 v[92:95], v51 offset:4096
    s_waitcnt lgkmcnt(0)
    s_mov_b64 exec, 1
    ds_add_u32 v2, v3 offset:32
    s_mov_b64 exec, -1

    v_mfma_f32_16x16x32_bf16 v[128:131], v[64:67], v[32:35], 0
    v_mfma_f32_16x16x32_bf16 v[132:135], v[80:83], v[32:35], 0
    v_mfma_f32_16x16x32_bf16 v[128:131], v[68:71], v[36:39], v[128:131]
    v_mfma_f32_16x16x32_bf16 v[132:135], v[84:87], v[36:39], v[132:135]
    v_mfma_f32_16x16x32_bf16 v[128:131], v[72:75], v[40:43], v[128:131]
    v_mfma_f32_16x16x32_bf16 v[132:135], v[88:91], v[40:43], v[132:135]
    v_mfma_f32_16x16x32_bf16 v[128:131], v[76:79], v[44:47], v[128:131]
    v_mfma_f32_16x16x32_bf16 v[132:135], v[92:95], v[44:47], v[132:135]
    s_mov_b32 s32, 0x3db504f3
    s_mov_b32 s33, 0x3fb8aa3b
    v_and_b32 v55, 1, v7
    v_lshlrev_b32 v55, 5, v55
    v_add_u32 v55, 152320, v55
    s_lshl_b32 s59, s31, 2
    v_add_u32 v56, s59, v55

    s_nop 3
    v_cvt_pk_bf16_f32 v53, v128, v129
    v_lshlrev_b32 v128, 16, v53
    v_and_b32 v129, 0xffff0000, v53
    v_mul_f32 v128, s32, v128
    v_mul_f32 v129, s32, v129
    v_cvt_pk_bf16_f32 v53, v128, v129
    v_lshlrev_b32 v128, 16, v53
    v_and_b32 v129, 0xffff0000, v53

    v_cvt_pk_bf16_f32 v53, v130, v131
    v_lshlrev_b32 v130, 16, v53
    v_and_b32 v131, 0xffff0000, v53
    v_mul_f32 v130, s32, v130
    v_mul_f32 v131, s32, v131
    v_cvt_pk_bf16_f32 v53, v130, v131
    v_lshlrev_b32 v130, 16, v53
    v_and_b32 v131, 0xffff0000, v53

    v_cvt_pk_bf16_f32 v53, v132, v133
    v_lshlrev_b32 v132, 16, v53
    v_and_b32 v133, 0xffff0000, v53
    v_mul_f32 v132, s32, v132
    v_mul_f32 v133, s32, v133
    v_cvt_pk_bf16_f32 v53, v132, v133
    v_lshlrev_b32 v132, 16, v53
    v_and_b32 v133, 0xffff0000, v53

    v_cvt_pk_bf16_f32 v53, v134, v135
    v_lshlrev_b32 v134, 16, v53
    v_and_b32 v135, 0xffff0000, v53
    v_mul_f32 v134, s32, v134
    v_mul_f32 v135, s32, v135
    v_cvt_pk_bf16_f32 v53, v134, v135
    v_lshlrev_b32 v134, 16, v53
    v_and_b32 v135, 0xffff0000, v53

    v_max3_f32 v54, v128, v129, v130
    v_max3_f32 v54, v54, v131, v132
    v_max3_f32 v54, v54, v133, v134
    v_max_f32 v54, v54, v135

    v_mov_b32 v53, v54
    s_nop 1
    v_permlane16_swap_b32 v53, v54
    s_nop 0
    v_max_f32 v54, v54, v53
    v_mov_b32 v53, v54
    s_nop 1
    v_permlane32_swap_b32 v53, v54
    s_nop 0
    v_max_f32 v54, v54, v53
    s_mov_b64 exec, 3
    ds_write_b32 v56, v54
    s_mov_b64 exec, -1
    s_waitcnt lgkmcnt(0)

    s_mov_b64 exec, 1
    ds_add_u32 v2, v3 offset:28
    s_mov_b64 exec, -1

    v_and_b32 v56, 1, v7
    v_lshlrev_b32 v56, 6, v56
    v_lshl_add_u32 v56, v6, 4, v56
    v_add_u32 v56, 151296, v56
    s_lshl_b32 s59, s31, 7
    v_add_u32 v57, s59, v56

Lsp_26:
    ds_read_b32 v4, v2 offset:28
    s_waitcnt lgkmcnt(0)
    v_readfirstlane_b32 s59, v4
    s_cmp_ge_u32 s59, 8
    s_cbranch_scc1 Lspx_27
    s_cmp_eq_u32 s57, 0
    s_cbranch_scc1 Lspx_27
    s_sub_u32 s57, s57, 1

    s_branch Lsp_26
Lspx_27:

    ds_read_b128 v[60:63], v55
    ds_read_b128 v[64:67], v55 offset:16
    s_waitcnt lgkmcnt(0)
    v_max3_f32 v54, v60, v61, v62
    v_max3_f32 v54, v54, v63, v64
    v_max3_f32 v54, v54, v65, v66
    v_max_f32 v54, v54, v67
    v_mul_f32 v54, s33, v54
    v_and_b32 v54, 0xffffff00, v54

    v_fma_f32 v128, v128, s33, -v54
    v_fma_f32 v129, v129, s33, -v54
    v_fma_f32 v130, v130, s33, -v54
    v_fma_f32 v131, v131, s33, -v54
    v_fma_f32 v132, v132, s33, -v54
    v_fma_f32 v133, v133, s33, -v54
    v_fma_f32 v134, v134, s33, -v54
    v_fma_f32 v135, v135, s33, -v54
    v_exp_f32 v128, v128
    v_exp_f32 v129, v129
    v_exp_f32 v130, v130
    v_exp_f32 v131, v131
    v_exp_f32 v132, v132
    v_exp_f32 v133, v133
    v_exp_f32 v134, v134
    v_exp_f32 v135, v135
    s_nop 0
    v_cvt_pk_bf16_f32 v64, v128, v129
    v_cvt_pk_bf16_f32 v65, v130, v131
    v_cvt_pk_bf16_f32 v66, v132, v133
    v_cvt_pk_bf16_f32 v67, v134, v135
    s_mov_b64 exec, s[42:43]
    ds_write_b128 v57, v[64:67]
    s_mov_b64 exec, -1
    s_waitcnt lgkmcnt(0)

    s_mov_b64 exec, 1
    ds_add_u32 v2, v3 offset:36
    s_mov_b64 exec, -1

    v_lshl_add_u32 v57, v6, 2, v8
    v_and_b32 v58, 7, v57
    v_lshlrev_b32 v58, 1, v58
    v_lshrrev_b32 v59, 1, v9
    s_lshl_b32 s59, s31, 1
    v_add_u32 v60, s59, v59
    v_xor_b32 v61, v60, v58
    v_lshlrev_b32 v57, 8, v57
    v_and_b32 v59, 1, v9
    v_lshl_add_u32 v57, v59, 3, v57
    v_add_u32 v57, 65536, v57
    v_lshl_add_u32 v61, v61, 4, v57
    v_mov_b32 v96, 0x3f803f80
    v_mov_b32 v97, 0x3f803f80
    v_mov_b32 v98, 0x3f803f80
    v_mov_b32 v99, 0x3f803f80
    s_lshl_b32 s32, s29, 4
    s_add_u32 s32, s32, s35
    s_mul_i32 s32, s32, 1280
    s_lshl_b32 s33, s31, 6
    s_add_u32 s33, s33, s32

    s_add_u32 s48, s26, s33
    s_addc_u32 s49, s27, 0
    s_add_u32 s48, s48, 131072
    s_addc_u32 s49, s49, 0
    s_add_u32 s50, s48, 1048576
    s_addc_u32 s51, s49, 0
    v_and_b32 v57, 1, v7
    v_lshlrev_b32 v57, 9, v57
    v_add_u32 v57, v57, v29

Lsp_28:
    ds_read_b32 v4, v2 offset:36
    s_waitcnt lgkmcnt(0)
    v_readfirstlane_b32 s59, v4
    s_cmp_ge_u32 s59, 8
    s_cbranch_scc1 Lspx_29
    s_cmp_eq_u32 s57, 0
    s_cbranch_scc1 Lspx_29
    s_sub_u32 s57, s57, 1

    s_branch Lsp_28
Lspx_29:

    ds_read_b128 v[64:67], v56 offset:0
    ds_read_b128 v[68:71], v56 offset:128
    ds_read_b128 v[72:75], v56 offset:256
    ds_read_b128 v[76:79], v56 offset:384
    ds_read_b128 v[80:83], v56 offset:512
    ds_read_b128 v[84:87], v56 offset:640
    ds_read_b128 v[88:91], v56 offset:768
    ds_read_b128 v[92:95], v56 offset:896
    s_waitcnt lgkmcnt(0)
    v_mfma_f32_16x16x32_bf16 v[108:111], v[96:99], v[64:67], 0
    v_mfma_f32_16x16x32_bf16 v[108:111], v[96:99], v[68:71], v[108:111]
    v_mfma_f32_16x16x32_bf16 v[108:111], v[96:99], v[72:75], v[108:111]
    v_mfma_f32_16x16x32_bf16 v[108:111], v[96:99], v[76:79], v[108:111]
    v_mfma_f32_16x16x32_bf16 v[108:111], v[96:99], v[80:83], v[108:111]
    v_mfma_f32_16x16x32_bf16 v[108:111], v[96:99], v[84:87], v[108:111]
    v_mfma_f32_16x16x32_bf16 v[108:111], v[96:99], v[88:91], v[108:111]
    v_mfma_f32_16x16x32_bf16 v[108:111], v[96:99], v[92:95], v[108:111]
    ds_read_b32 v53, v2 offset:88
    s_waitcnt lgkmcnt(0)
    v_readfirstlane_b32 s20, v53
    s_cmp_eq_u32 s31, 0
    s_cbranch_scc0 L_pt1
    s_lshl_b32 s32, s29, 4
    s_add_u32 s32, s32, s35
    s_mul_i32 s32, s32, 1280
    s_add_u32 s12, s26, s32
    s_addc_u32 s13, s27, 0
    s_add_u32 s12, s12, 1179648
    s_addc_u32 s13, s13, 0
    v_and_b32 v20, 15, v1
    v_min_u32 v20, 9, v20
    v_lshlrev_b32 v20, 7, v20
    global_load_dword v21, v20, s[12:13] sc1
    s_branch L_pt_done
L_pt1:
    s_cmp_eq_u32 s31, 1
    s_cbranch_scc0 L_pt_done
    s_cmp_lt_u32 s34, 27
    s_cbranch_scc0 L_pt_done
    s_lshr_b32 s32, s34, 1
    s_mul_i32 s33, s28, 9
    s_add_u32 s32, s32, s33
    s_lshl_b32 s32, s32, 9
    s_and_b32 s33, s34, 1
    s_lshl_b32 s33, s33, 8
    s_add_u32 s32, s32, s33
    s_add_u32 s32, s32, 2064384
    s_mul_i32 s33, s28, 2304
    s_sub_u32 s12, s34, 18
    s_lshl_b32 s12, s12, 8
    s_add_u32 s33, s33, s12
    s_add_u32 s33, s33, 1572864
    s_cmp_lt_u32 s34, 18
    s_cselect_b32 s32, s32, s33
    s_add_u32 s12, s26, s32
    s_addc_u32 s13, s27, 0
    v_lshlrev_b32 v20, 2, v1
    global_load_dword v21, v20, s[12:13] sc1
L_pt_done:

Lsp_30:
    ds_read_b32 v4, v2 offset:40
    s_waitcnt lgkmcnt(0)
    v_readfirstlane_b32 s59, v4
    s_cmp_ge_u32 s59, 4
    s_cbranch_scc1 Lspx_31
    s_cmp_eq_u32 s57, 0
    s_cbranch_scc1 Lspx_31
    s_sub_u32 s57, s57, 1
    s_sleep 1
    s_branch Lsp_30
Lspx_31:

    ds_read_b64_tr_b16 v[112:113], v61 offset:0
    ds_read_b64_tr_b16 v[114:115], v61 offset:4096
    ds_read_b64_tr_b16 v[116:117], v61 offset:8192
    ds_read_b64_tr_b16 v[118:119], v61 offset:12288
    s_waitcnt lgkmcnt(0)
    v_mfma_f32_16x16x32_bf16 v[100:103], v[112:115], v[64:67], 0
    v_mfma_f32_16x16x32_bf16 v[100:103], v[116:119], v[68:71], v[100:103]
Lsp_32:
    ds_read_b32 v4, v2 offset:44
    s_waitcnt lgkmcnt(0)
    v_readfirstlane_b32 s59, v4
    s_cmp_ge_u32 s59, 4
    s_cbranch_scc1 Lspx_33
    s_cmp_eq_u32 s57, 0
    s_cbranch_scc1 Lspx_33
    s_sub_u32 s57, s57, 1
    s_sleep 1
    s_branch Lsp_32
Lspx_33:

    ds_read_b64_tr_b16 v[112:113], v61 offset:16384
    ds_read_b64_tr_b16 v[114:115], v61 offset:20480
    ds_read_b64_tr_b16 v[116:117], v61 offset:24576
    ds_read_b64_tr_b16 v[118:119], v61 offset:28672
    s_waitcnt lgkmcnt(0)
    v_mfma_f32_16x16x32_bf16 v[100:103], v[112:115], v[72:75], v[100:103]
    v_mfma_f32_16x16x32_bf16 v[100:103], v[116:119], v[76:79], v[100:103]
Lsp_34:
    ds_read_b32 v4, v2 offset:48
    s_waitcnt lgkmcnt(0)
    v_readfirstlane_b32 s59, v4
    s_cmp_ge_u32 s59, 4
    s_cbranch_scc1 Lspx_35
    s_cmp_eq_u32 s57, 0
    s_cbranch_scc1 Lspx_35
    s_sub_u32 s57, s57, 1

    s_branch Lsp_34
Lspx_35:

    ds_read_b64_tr_b16 v[112:113], v61 offset:32768
    ds_read_b64_tr_b16 v[114:115], v61 offset:36864
    ds_read_b64_tr_b16 v[116:117], v61 offset:40960
    ds_read_b64_tr_b16 v[118:119], v61 offset:45056
    s_waitcnt lgkmcnt(0)
    v_mfma_f32_16x16x32_bf16 v[100:103], v[112:115], v[80:83], v[100:103]
    v_mfma_f32_16x16x32_bf16 v[100:103], v[116:119], v[84:87], v[100:103]
Lsp_36:
    ds_read_b32 v4, v2 offset:52
    s_waitcnt lgkmcnt(0)
    v_readfirstlane_b32 s59, v4
    s_cmp_ge_u32 s59, 4
    s_cbranch_scc1 Lspx_37
    s_cmp_eq_u32 s57, 0
    s_cbranch_scc1 Lspx_37
    s_sub_u32 s57, s57, 1

    s_branch Lsp_36
Lspx_37:

    ds_read_b64_tr_b16 v[112:113], v61 offset:49152
    ds_read_b64_tr_b16 v[114:115], v61 offset:53248
    ds_read_b64_tr_b16 v[116:117], v61 offset:57344
    ds_read_b64_tr_b16 v[118:119], v61 offset:61440
    s_waitcnt lgkmcnt(0)
    v_mfma_f32_16x16x32_bf16 v[100:103], v[112:115], v[88:91], v[100:103]
    v_mfma_f32_16x16x32_bf16 v[100:103], v[116:119], v[92:95], v[100:103]
    s_nop 7
    v_bfi_b32 v100, v5, s52, v100
    v_bfi_b32 v101, v5, s53, v101
    v_bfi_b32 v102, v5, s54, v102
    v_bfi_b32 v103, v5, s55, v103
    s_mov_b64 exec, s[42:43]
    global_store_dwordx4 v57, v[100:103], s[50:51]
    s_cmp_eq_u32 s20, 1
    s_cbranch_scc1 Lds_38
    global_store_dwordx4 v57, v[100:103], s[48:49] sc1
Lds_38:
    s_mov_b64 exec, -1
    s_cmp_eq_u32 s31, 0
    s_cbranch_scc0 L_nostat
    v_mov_b32_dpp v112, v54 row_newbcast:0 row_mask:0xf bank_mask:0xf
    v_mov_b32_dpp v113, v108 row_newbcast:0 row_mask:0xf bank_mask:0xf
    v_mov_b32_dpp v114, v54 row_newbcast:1 row_mask:0xf bank_mask:0xf
    v_mov_b32_dpp v115, v108 row_newbcast:1 row_mask:0xf bank_mask:0xf

    v_bfi_b32 v112, v5, s52, v112
    v_bfi_b32 v113, v5, s53, v113
    v_bfi_b32 v114, v5, s54, v114
    v_bfi_b32 v115, v5, s55, v115
    s_mov_b64 exec, 0xff
    global_store_dwordx4 v10, v[112:115], s[50:51] offset:1024
    s_cmp_eq_u32 s20, 1
    s_cbranch_scc1 Lds_39
    global_store_dwordx4 v10, v[112:115], s[48:49] offset:1024 sc1
Lds_39:
    s_mov_b64 exec, -1
L_nostat:
    s_cmp_lt_u32 s34, 18
    s_cbranch_scc1 L_ffn
    s_cmp_lt_u32 s34, 27
    s_cbranch_scc1 L_wo

    s_mov_b64 exec, 1
    ds_add_u32 v2, v3 offset:60
    s_mov_b64 exec, -1

    s_branch L_fin
L_wo:
    s_lshr_b32 s32, s31, 2
    s_lshl_b32 s33, s28, 1
    s_add_u32 s32, s32, s33
    s_lshl_b32 s32, s32, 4
    s_and_b32 s33, s31, 3
    s_lshl_b32 s33, s33, 2
    s_add_u32 s50, s33, s32
    s_mul_i32 s50, s50, 1280
    s_mul_i32 s32, s32, 1280

    s_add_u32 s48, s26, s50
    s_addc_u32 s49, s27, 0
    s_add_u32 s48, s48, 1179648
    s_addc_u32 s49, s49, 0
    s_add_u32 s50, s26, s32
    s_addc_u32 s51, s27, 0
    s_add_u32 s50, s50, 1180672
    s_addc_u32 s51, s51, 0
    v_add_u32 v30, s33, v1
    v_and_b32 v30, 15, v30
    v_mul_u32_u24 v30, 1280, v30
    s_lshl_b32 s33, s31, 10
    s_add_u32 s33, s33, 65536
    v_add_u32 v26, s33, v10
    v_add_u32 v27, 65536, v10
    v_lshrrev_b32 v31, 3, v1
    v_lshlrev_b32 v31, 6, v31
    v_lshl_add_u32 v31, v9, 4, v31
    v_and_b32 v28, 1, v8
    v_lshl_add_u32 v31, v28, 3, v31
    s_and_b32 s33, s31, 3
    s_lshl_b32 s33, s33, 10
    s_add_u32 s33, s33, 73728
    v_add_u32 v28, s33, v31
    v_add_u32 v24, s33, v29
    v_add_u32 v53, 131072, v25
    v_add_u32 v54, 0, v25
    s_mul_i32 s32, s28, 2304
    s_sub_u32 s33, s34, 18
    s_lshl_b32 s33, s33, 8
    s_add_u32 s32, s32, s33
    s_and_b32 s33, s31, 3
    s_lshl_b32 s33, s33, 6
    s_add_u32 s32, s32, s33

    s_add_u32 s44, s26, s32
    s_addc_u32 s45, s27, 0
    s_add_u32 s44, s44, 524288
    s_addc_u32 s45, s45, 0
    s_add_u32 s46, s44, 1048576
    s_addc_u32 s47, s45, 0
Lsp_40:
    ds_read_b32 v4, v2 offset:56
    s_waitcnt lgkmcnt(0)
    v_readfirstlane_b32 s59, v4
    s_cmp_ge_u32 s59, 4
    s_cbranch_scc1 Lspx_41
    s_cmp_eq_u32 s57, 0
    s_cbranch_scc1 Lspx_41
    s_sub_u32 s57, s57, 1
    s_sleep 1
    s_branch Lsp_40
Lspx_41:

    s_mov_b32 s7, 1
    global_load_dwordx4 v[48:51], v30, s[50:51] sc1
    global_load_dwordx4 v[32:35], v10, s[48:49] sc1
    global_load_dwordx4 v[36:39], v10, s[48:49] offset:1280 sc1
    global_load_dwordx4 v[40:43], v10, s[48:49] offset:2560 sc1
    global_load_dwordx4 v[44:47], v10, s[48:49] offset:3840 sc1
    s_cmp_lt_u32 s31, 4
    s_cbranch_scc0 L_wo_poll

    ds_read_b64_tr_b16 v[64:65], v53 offset:0
    ds_read_b64_tr_b16 v[66:67], v53 offset:2048
    ds_read_b64_tr_b16 v[68:69], v53 offset:4096
    ds_read_b64_tr_b16 v[70:71], v53 offset:6144
    ds_read_b64_tr_b16 v[72:73], v53 offset:8192
    ds_read_b64_tr_b16 v[74:75], v53 offset:10240
    ds_read_b64_tr_b16 v[76:77], v53 offset:12288
    ds_read_b64_tr_b16 v[78:79], v53 offset:14336
    ds_read_b64_tr_b16 v[80:81], v53 offset:16384
    ds_read_b64_tr_b16 v[82:83], v54 offset:0
    ds_read_b64_tr_b16 v[84:85], v54 offset:2048
    ds_read_b64_tr_b16 v[86:87], v54 offset:4096
    ds_read_b64_tr_b16 v[88:89], v54 offset:6144
    ds_read_b64_tr_b16 v[90:91], v54 offset:8192
    ds_read_b64_tr_b16 v[92:93], v54 offset:10240
    ds_read_b64_tr_b16 v[94:95], v54 offset:12288
    ds_read_b64_tr_b16 v[96:97], v54 offset:14336
    ds_read_b64_tr_b16 v[98:99], v54 offset:16384
    ds_read_b64_tr_b16 v[100:101], v54 offset:18432
    ds_read_b64_tr_b16 v[102:103], v54 offset:20480
    ds_read_b64_tr_b16 v[104:105], v54 offset:22528
    ds_read_b64_tr_b16 v[106:107], v54 offset:24576
    ds_read_b64_tr_b16 v[108:109], v54 offset:26624
    ds_read_b64_tr_b16 v[110:111], v54 offset:28672
    ds_read_b64_tr_b16 v[112:113], v54 offset:30720
    ds_read_b64_tr_b16 v[114:115], v54 offset:32768
    ds_read_b64_tr_b16 v[116:117], v54 offset:34816
    ds_read_b64_tr_b16 v[118:119], v54 offset:36864
    ds_read_b64_tr_b16 v[120:121], v54 offset:38912
    ds_read_b64_tr_b16 v[122:123], v54 offset:40960
    ds_read_b64_tr_b16 v[124:125], v54 offset:43008
    ds_read_b64_tr_b16 v[126:127], v54 offset:45056
L_wo_poll:
    s_mov_b32 s4, 64
    s_mov_b32 s5, -1048576
    s_branch Lplp_44
Lpl_42:
    global_load_dwordx4 v[48:51], v30, s[50:51] sc1
    global_load_dwordx4 v[32:35], v10, s[48:49] offset:0 sc1
    global_load_dwordx4 v[36:39], v10, s[48:49] offset:1280 sc1
    global_load_dwordx4 v[40:43], v10, s[48:49] offset:2560 sc1
    global_load_dwordx4 v[44:47], v10, s[48:49] offset:3840 sc1
Lplp_44:
    s_waitcnt vmcnt(0)
    v_xor_b32 v48, s52, v48
    v_xor_b32 v49, s53, v49
    v_xor_b32 v50, s54, v50
    v_xor_b32 v51, s55, v51
    v_or3_b32 v31, v48, v49, v50
    v_or_b32 v31, v31, v51
    v_xor_b32 v32, s52, v32
    v_xor_b32 v33, s53, v33
    v_xor_b32 v34, s54, v34
    v_xor_b32 v35, s55, v35
    v_or3_b32 v31, v31, v32, v33
    v_or3_b32 v31, v31, v34, v35
    v_xor_b32 v36, s52, v36
    v_xor_b32 v37, s53, v37
    v_xor_b32 v38, s54, v38
    v_xor_b32 v39, s55, v39
    v_or3_b32 v31, v31, v36, v37
    v_or3_b32 v31, v31, v38, v39
    v_xor_b32 v40, s52, v40
    v_xor_b32 v41, s53, v41
    v_xor_b32 v42, s54, v42
    v_xor_b32 v43, s55, v43
    v_or3_b32 v31, v31, v40, v41
    v_or3_b32 v31, v31, v42, v43
    v_xor_b32 v44, s52, v44
    v_xor_b32 v45, s53, v45
    v_xor_b32 v46, s54, v46
    v_xor_b32 v47, s55, v47
    v_or3_b32 v31, v31, v44, v45
    v_or3_b32 v31, v31, v46, v47
    v_and_b32 v31, 0xff, v31
    v_cmp_ne_u32 vcc, 0, v31
    s_cbranch_vccz Lplx_43
    s_cmp_eq_u32 s58, 0
    s_cbranch_scc1 Lplx_43
    s_sub_u32 s58, s58, 1

    s_sleep 1
    s_cmp_eq_u32 s4, 0
    s_cbranch_scc1 Lplt_45
    s_sub_u32 s4, s4, 1
    s_branch Lpl_42
Lplt_45:

    s_ashr_i32 s6, s5, 31
    s_add_u32 s48, s48, s5
    s_addc_u32 s49, s49, s6
    s_add_u32 s50, s50, s5
    s_addc_u32 s51, s51, s6
    s_sub_u32 s5, 0, s5
    s_branch Lpl_42
Lplx_43:
    v_cmp_gt_u32 vcc, 32, v1
    s_nop 1
    v_cndmask_b32 v52, v50, v48, vcc
    v_cndmask_b32 v55, v51, v49, vcc
    v_mov_b32 v56, v52

    s_nop 1
    v_max_f32_dpp v56, v56, v56 row_ror:8 row_mask:0xf bank_mask:0xf
    s_nop 1
    v_max_f32_dpp v56, v56, v56 row_ror:4 row_mask:0xf bank_mask:0xf
    s_nop 1
    v_max_f32_dpp v56, v56, v56 row_ror:2 row_mask:0xf bank_mask:0xf
    s_nop 1
    v_max_f32_dpp v56, v56, v56 row_ror:1 row_mask:0xf bank_mask:0xf
    v_sub_f32 v52, v52, v56
    v_exp_f32 v52, v52
    s_nop 0
    v_mul_f32 v55, v55, v52

    s_nop 1
    v_add_f32_dpp v55, v55, v55 row_ror:8 row_mask:0xf bank_mask:0xf
    s_nop 1
    v_add_f32_dpp v55, v55, v55 row_ror:4 row_mask:0xf bank_mask:0xf
    s_nop 1
    v_add_f32_dpp v55, v55, v55 row_ror:2 row_mask:0xf bank_mask:0xf
    s_nop 1
    v_add_f32_dpp v55, v55, v55 row_ror:1 row_mask:0xf bank_mask:0xf
    v_rcp_f32 v55, v55
    s_nop 0
    v_mul_f32 v52, v52, v55
    s_nop 1

    v_mov_b32_dpp v56, v52 row_newbcast:0 row_mask:0xf bank_mask:0xf
    v_mov_b32_dpp v57, v52 row_newbcast:1 row_mask:0xf bank_mask:0xf
    v_mov_b32_dpp v58, v52 row_newbcast:2 row_mask:0xf bank_mask:0xf
    v_mov_b32_dpp v59, v52 row_newbcast:3 row_mask:0xf bank_mask:0xf
    v_mul_f32 v60, v32, v56
    v_mul_f32 v61, v33, v56
    v_mul_f32 v62, v34, v56
    v_mul_f32 v63, v35, v56
    v_fmac_f32 v60, v36, v57
    v_fmac_f32 v61, v37, v57
    v_fmac_f32 v62, v38, v57
    v_fmac_f32 v63, v39, v57
    v_fmac_f32 v60, v40, v58
    v_fmac_f32 v61, v41, v58
    v_fmac_f32 v62, v42, v58
    v_fmac_f32 v63, v43, v58
    v_fmac_f32 v60, v44, v59
    v_fmac_f32 v61, v45, v59
    v_fmac_f32 v62, v46, v59
    v_fmac_f32 v63, v47, v59
    ds_write_b128 v26, v[60:63]
    s_waitcnt lgkmcnt(0)

    s_barrier
    s_cmp_lt_u32 s31, 4
    s_cbranch_scc0 L_wo_done

    ds_read_b128 v[32:35], v27 offset:0
    ds_read_b128 v[36:39], v27 offset:1024
    ds_read_b128 v[40:43], v27 offset:2048
    ds_read_b128 v[44:47], v27 offset:3072
    ds_read_b128 v[48:51], v27 offset:4096
    ds_read_b128 v[52:55], v27 offset:5120
    ds_read_b128 v[56:59], v27 offset:6144
    ds_read_b128 v[60:63], v27 offset:7168
    s_waitcnt lgkmcnt(4)
    v_pk_add_f32 v[32:33], v[32:33], v[36:37]
    v_pk_add_f32 v[34:35], v[34:35], v[38:39]
    v_pk_add_f32 v[40:41], v[40:41], v[44:45]
    v_pk_add_f32 v[42:43], v[42:43], v[46:47]
    v_pk_add_f32 v[32:33], v[32:33], v[40:41]
    v_pk_add_f32 v[34:35], v[34:35], v[42:43]
    v_cvt_pk_bf16_f32 v32, v32, v33
    v_cvt_pk_bf16_f32 v33, v34, v35

    ds_write_b64 v28, v[32:33]
    s_waitcnt lgkmcnt(1)
    v_pk_add_f32 v[48:49], v[48:49], v[52:53]
    v_pk_add_f32 v[50:51], v[50:51], v[54:55]
    v_pk_add_f32 v[56:57], v[56:57], v[60:61]
    v_pk_add_f32 v[58:59], v[58:59], v[62:63]
    v_pk_add_f32 v[48:49], v[48:49], v[56:57]
    v_pk_add_f32 v[50:51], v[50:51], v[58:59]
    v_cvt_pk_bf16_f32 v48, v48, v49
    v_cvt_pk_bf16_f32 v49, v50, v51

    ds_write_b64 v28, v[48:49] offset:512
    s_waitcnt lgkmcnt(0)
    ds_read_b128 v[128:131], v24 offset:0
    ds_read_b128 v[132:135], v24 offset:64
    ds_read_b128 v[136:139], v24 offset:128
    ds_read_b128 v[140:143], v24 offset:192
    ds_read_b128 v[144:147], v24 offset:256
    ds_read_b128 v[148:151], v24 offset:320
    ds_read_b128 v[152:155], v24 offset:384
    ds_read_b128 v[156:159], v24 offset:448
    s_waitcnt lgkmcnt(7)
    v_mfma_f32_16x16x32_bf16 v[60:63], v[64:67], v[128:131], 0
    s_waitcnt lgkmcnt(6)
    v_mfma_f32_16x16x32_bf16 v[60:63], v[68:71], v[132:135], v[60:63]
    s_waitcnt lgkmcnt(5)
    v_mfma_f32_16x16x32_bf16 v[60:63], v[72:75], v[136:139], v[60:63]
    s_waitcnt lgkmcnt(4)
    v_mfma_f32_16x16x32_bf16 v[60:63], v[76:79], v[140:143], v[60:63]
    s_waitcnt lgkmcnt(3)
    v_mfma_f32_16x16x32_bf16 v[60:63], v[80:83], v[144:147], v[60:63]
    s_waitcnt lgkmcnt(2)
    v_mfma_f32_16x16x32_bf16 v[60:63], v[84:87], v[148:151], v[60:63]
    s_waitcnt lgkmcnt(1)
    v_mfma_f32_16x16x32_bf16 v[60:63], v[88:91], v[152:155], v[60:63]
    s_waitcnt lgkmcnt(0)
    v_mfma_f32_16x16x32_bf16 v[60:63], v[92:95], v[156:159], v[60:63]
    ds_read_b128 v[128:131], v24 offset:512
    ds_read_b128 v[132:135], v24 offset:576
    ds_read_b128 v[136:139], v24 offset:640
    ds_read_b128 v[140:143], v24 offset:704
    ds_read_b128 v[144:147], v24 offset:768
    ds_read_b128 v[148:151], v24 offset:832
    ds_read_b128 v[152:155], v24 offset:896
    ds_read_b128 v[156:159], v24 offset:960
    s_waitcnt lgkmcnt(7)
    v_mfma_f32_16x16x32_bf16 v[60:63], v[96:99], v[128:131], v[60:63]
    s_waitcnt lgkmcnt(6)
    v_mfma_f32_16x16x32_bf16 v[60:63], v[100:103], v[132:135], v[60:63]
    s_waitcnt lgkmcnt(5)
    v_mfma_f32_16x16x32_bf16 v[60:63], v[104:107], v[136:139], v[60:63]
    s_waitcnt lgkmcnt(4)
    v_mfma_f32_16x16x32_bf16 v[60:63], v[108:111], v[140:143], v[60:63]
    s_waitcnt lgkmcnt(3)
    v_mfma_f32_16x16x32_bf16 v[60:63], v[112:115], v[144:147], v[60:63]
    s_waitcnt lgkmcnt(2)
    v_mfma_f32_16x16x32_bf16 v[60:63], v[116:119], v[148:151], v[60:63]
    s_waitcnt lgkmcnt(1)
    v_mfma_f32_16x16x32_bf16 v[60:63], v[120:123], v[152:155], v[60:63]
    s_waitcnt lgkmcnt(0)
    v_mfma_f32_16x16x32_bf16 v[60:63], v[124:127], v[156:159], v[60:63]
    s_nop 7
    v_bfi_b32 v60, v5, s52, v60
    v_bfi_b32 v61, v5, s53, v61
    v_bfi_b32 v62, v5, s54, v62
    v_bfi_b32 v63, v5, s55, v63
    s_mov_b64 exec, s[40:41]
    global_store_dwordx4 v29, v[60:63], s[46:47]
    global_store_dwordx4 v29, v[60:63], s[44:45] sc1
    s_mov_b64 exec, -1
L_wo_done:
    s_cmp_eq_u32 s31, 0
    s_cbranch_scc0 L_fin
    s_mul_i32 s50, s28, 9
    s_add_u32 s50, s50, s34
    s_sub_u32 s50, s50, 18
    v_lshrrev_b32 v30, 1, v1
    v_mul_u32_u24 v26, 2304, v30
    v_and_b32 v31, 1, v1
    v_lshlrev_b32 v31, 4, v31
    v_add_u32 v112, v26, v31
    s_lshl_b32 s32, s50, 5

    s_add_u32 s48, s26, s32
    s_addc_u32 s49, s27, 0
    s_add_u32 s48, s48, 655360
    s_addc_u32 s49, s49, 0
    s_add_u32 s46, s26, s32
    s_addc_u32 s47, s27, 0
    s_add_u32 s46, s46, 524288
    s_addc_u32 s47, s47, 0
    s_lshl_b32 s33, s50, 4
    s_add_u32 s22, s22, s33
    s_addc_u32 s23, s23, 0
    v_lshrrev_b32 v27, 1, v31
    v_add_u32 v27, s33, v27
    buffer_load_dwordx2 v[72:73], v27, s[36:39], 0 offen
    v_and_b32 v27, 7, v30
    v_cmp_eq_u32 vcc, s28, v27
    v_mul_u32_u24 v27, 2304, v27
    v_add_u32 v27, v27, v31
    v_mov_b32 v28, 1048576
    v_cndmask_b32 v28, 0, v28, vcc
    v_add_u32 v27, v27, v28
    v_ashrrev_i32 v28, 20, v28
    s_mov_b32 s33, s50

    v_add_u32 v113, 73728, v112
    v_add_u32 v114, 147456, v112
    v_add_u32 v115, 221184, v112
    v_and_b32 v116, 31, v1
    v_lshrrev_b32 v116, 1, v116
    v_mul_u32_u24 v116, 2304, v116
    v_add_u32 v116, v116, v31
    v_add_u32 v116, 294912, v116

    s_mov_b32 s4, 64
    s_mov_b32 s5, -1048576
Lpl_46:
    global_load_dwordx4 v[68:71], v27, s[46:47] sc1
    s_waitcnt vmcnt(0)
    v_xor_b32 v68, s52, v68
    v_xor_b32 v69, s53, v69
    v_xor_b32 v70, s54, v70
    v_xor_b32 v71, s55, v71
    v_or3_b32 v29, v68, v69, v70
    v_or_b32 v29, v29, v71
    v_and_b32 v29, 0xff, v29
    v_cmp_ne_u32 vcc, 0, v29
    s_cbranch_vccz Lplx_47
    s_cmp_eq_u32 s58, 0
    s_cbranch_scc1 Lplx_47
    s_sub_u32 s58, s58, 1

    s_sleep 4
    s_cmp_eq_u32 s4, 0
    s_cbranch_scc1 Lplt_49
    s_sub_u32 s4, s4, 1
    s_branch Lpl_46
Lplt_49:

    v_mad_i32_i24 v27, v28, s5, v27
    s_sub_u32 s5, 0, s5
    s_branch Lpl_46
Lplx_47:
    s_nop 0
    v_add_f32_dpp v68, v68, v68 row_ror:2 row_mask:0xf bank_mask:0xf
    v_add_f32_dpp v69, v69, v69 row_ror:2 row_mask:0xf bank_mask:0xf
    v_add_f32_dpp v70, v70, v70 row_ror:2 row_mask:0xf bank_mask:0xf
    v_add_f32_dpp v71, v71, v71 row_ror:2 row_mask:0xf bank_mask:0xf
    s_nop 0
    v_add_f32_dpp v68, v68, v68 row_ror:4 row_mask:0xf bank_mask:0xf
    v_add_f32_dpp v69, v69, v69 row_ror:4 row_mask:0xf bank_mask:0xf
    v_add_f32_dpp v70, v70, v70 row_ror:4 row_mask:0xf bank_mask:0xf
    v_add_f32_dpp v71, v71, v71 row_ror:4 row_mask:0xf bank_mask:0xf
    s_nop 0
    v_add_f32_dpp v68, v68, v68 row_ror:8 row_mask:0xf bank_mask:0xf
    v_add_f32_dpp v69, v69, v69 row_ror:8 row_mask:0xf bank_mask:0xf
    v_add_f32_dpp v70, v70, v70 row_ror:8 row_mask:0xf bank_mask:0xf
    v_add_f32_dpp v71, v71, v71 row_ror:8 row_mask:0xf bank_mask:0xf
    v_cvt_pk_bf16_f32 v74, v68, v69
    v_cvt_pk_bf16_f32 v75, v70, v71
    v_lshlrev_b32 v68, 16, v74
    v_and_b32 v69, 0xffff0000, v74
    v_lshlrev_b32 v70, 16, v75
    v_and_b32 v71, 0xffff0000, v75
    v_lshlrev_b32 v76, 16, v72
    v_and_b32 v77, 0xffff0000, v72
    v_lshlrev_b32 v78, 16, v73
    v_and_b32 v79, 0xffff0000, v73
    v_add_f32 v68, v68, v76
    v_add_f32 v69, v69, v77
    v_add_f32 v70, v70, v78
    v_add_f32 v71, v71, v79
    v_cvt_pk_bf16_f32 v74, v68, v69
    v_cvt_pk_bf16_f32 v75, v70, v71
    v_lshlrev_b32 v68, 16, v74
    v_and_b32 v69, 0xffff0000, v74
    v_lshlrev_b32 v70, 16, v75
    v_and_b32 v71, 0xffff0000, v75

    s_mul_i32 s32, s28, 4608
    s_add_u32 s32, s32, 2064384
    v_and_b32 v80, 15, v1
    v_lshl_add_u32 v80, v80, 4, s32
    s_mov_b32 s4, 200
L_fg:
    global_load_dwordx4 v[76:79], v80, s[26:27] sc1
    s_waitcnt vmcnt(0)
    v_xor_b32 v76, s52, v76
    v_and_b32 v76, 0xff, v76
    v_cmp_ne_u32 vcc, 0, v76
    s_cbranch_vccz L_fgx
    s_cmp_eq_u32 s4, 0
    s_cbranch_scc1 L_fgx
    s_sub_u32 s4, s4, 1
    s_sleep 2
    s_branch L_fg
L_fgx:

Lpl_50:
    global_load_dwordx4 v[32:35], v112, s[48:49] sc1
    global_load_dwordx4 v[36:39], v113, s[48:49] sc1
    global_load_dwordx4 v[40:43], v114, s[48:49] sc1
    global_load_dwordx4 v[44:47], v115, s[48:49] sc1
    global_load_dwordx4 v[48:51], v116, s[48:49] sc1
    s_waitcnt vmcnt(0)
    v_xor_b32 v32, s52, v32
    v_xor_b32 v33, s53, v33
    v_xor_b32 v34, s54, v34
    v_xor_b32 v35, s55, v35
    v_or3_b32 v29, v32, v33, v34
    v_or_b32 v29, v29, v35
    v_xor_b32 v36, s52, v36
    v_xor_b32 v37, s53, v37
    v_xor_b32 v38, s54, v38
    v_xor_b32 v39, s55, v39
    v_or3_b32 v29, v29, v36, v37
    v_or3_b32 v29, v29, v38, v39
    v_xor_b32 v40, s52, v40
    v_xor_b32 v41, s53, v41
    v_xor_b32 v42, s54, v42
    v_xor_b32 v43, s55, v43
    v_or3_b32 v29, v29, v40, v41
    v_or3_b32 v29, v29, v42, v43
    v_xor_b32 v44, s52, v44
    v_xor_b32 v45, s53, v45
    v_xor_b32 v46, s54, v46
    v_xor_b32 v47, s55, v47
    v_or3_b32 v29, v29, v44, v45
    v_or3_b32 v29, v29, v46, v47
    v_xor_b32 v48, s52, v48
    v_xor_b32 v49, s53, v49
    v_xor_b32 v50, s54, v50
    v_xor_b32 v51, s55, v51
    v_or3_b32 v29, v29, v48, v49
    v_or3_b32 v29, v29, v50, v51
    v_and_b32 v29, 0xff, v29
    v_cmp_ne_u32 vcc, 0, v29
    s_cbranch_vccz Lplx_51
    s_cmp_eq_u32 s58, 0
    s_cbranch_scc1 Lplx_51
    s_sub_u32 s58, s58, 1

    s_branch Lpl_50
Lplx_51:
    v_cmp_gt_u32 vcc, 32, v1
    v_pk_add_f32 v[32:33], v[32:33], v[36:37]
    v_pk_add_f32 v[40:41], v[40:41], v[44:45]
    v_pk_add_f32 v[34:35], v[34:35], v[38:39]
    v_pk_add_f32 v[42:43], v[42:43], v[46:47]
    v_cndmask_b32 v48, 0, v48, vcc
    v_cndmask_b32 v49, 0, v49, vcc
    v_cndmask_b32 v50, 0, v50, vcc
    v_cndmask_b32 v51, 0, v51, vcc
    v_pk_add_f32 v[32:33], v[32:33], v[40:41]
    v_pk_add_f32 v[34:35], v[34:35], v[42:43]
    v_pk_add_f32 v[32:33], v[32:33], v[48:49]
    v_pk_add_f32 v[34:35], v[34:35], v[50:51]
    s_nop 0
    v_add_f32_dpp v32, v32, v32 row_ror:2 row_mask:0xf bank_mask:0xf
    v_add_f32_dpp v33, v33, v33 row_ror:2 row_mask:0xf bank_mask:0xf
    v_add_f32_dpp v34, v34, v34 row_ror:2 row_mask:0xf bank_mask:0xf
    v_add_f32_dpp v35, v35, v35 row_ror:2 row_mask:0xf bank_mask:0xf
    s_nop 0
    v_add_f32_dpp v32, v32, v32 row_ror:4 row_mask:0xf bank_mask:0xf
    v_add_f32_dpp v33, v33, v33 row_ror:4 row_mask:0xf bank_mask:0xf
    v_add_f32_dpp v34, v34, v34 row_ror:4 row_mask:0xf bank_mask:0xf
    v_add_f32_dpp v35, v35, v35 row_ror:4 row_mask:0xf bank_mask:0xf
    s_nop 0
    v_add_f32_dpp v32, v32, v32 row_ror:8 row_mask:0xf bank_mask:0xf
    v_add_f32_dpp v33, v33, v33 row_ror:8 row_mask:0xf bank_mask:0xf
    v_add_f32_dpp v34, v34, v34 row_ror:8 row_mask:0xf bank_mask:0xf
    v_add_f32_dpp v35, v35, v35 row_ror:8 row_mask:0xf bank_mask:0xf
    v_mov_b32 v36, v32
    v_mov_b32 v37, v33
    v_mov_b32 v38, v34
    v_mov_b32 v39, v35
    s_nop 0
    v_permlane16_swap_b32 v36, v32
    v_permlane16_swap_b32 v37, v33
    v_permlane16_swap_b32 v38, v34
    v_permlane16_swap_b32 v39, v35
    s_nop 0
    v_add_f32 v32, v32, v36
    v_add_f32 v33, v33, v37
    v_add_f32 v34, v34, v38
    v_add_f32 v35, v35, v39
    v_mov_b32 v36, v32
    v_mov_b32 v37, v33
    v_mov_b32 v38, v34
    v_mov_b32 v39, v35
    s_nop 0
    v_permlane32_swap_b32 v36, v32
    v_permlane32_swap_b32 v37, v33
    v_permlane32_swap_b32 v38, v34
    v_permlane32_swap_b32 v39, v35
    s_nop 0
    v_add_f32 v32, v32, v36
    v_add_f32 v33, v33, v37
    v_add_f32 v34, v34, v38
    v_add_f32 v35, v35, v39
    v_cvt_pk_bf16_f32 v36, v32, v33
    v_cvt_pk_bf16_f32 v37, v34, v35
    v_lshlrev_b32 v38, 3, v1
    v_lshlrev_b32 v32, 16, v36
    v_and_b32 v33, 0xffff0000, v36
    v_lshlrev_b32 v34, 16, v37
    v_and_b32 v35, 0xffff0000, v37
    v_add_f32 v32, v32, v68
    v_add_f32 v33, v33, v69
    v_add_f32 v34, v34, v70
    v_add_f32 v35, v35, v71
    v_cvt_pk_bf16_f32 v36, v32, v33
    v_cvt_pk_bf16_f32 v37, v34, v35
    v_lshlrev_b32 v90, 3, v1
    s_mov_b64 exec, 3
    global_store_dwordx2 v90, v[36:37], s[22:23]
    s_mov_b64 exec, -1
    s_cmp_eq_u32 s33, 0
    s_cbranch_scc0 L_noep
    s_lshl_b32 s32, s53, 8
    s_or_b32 s32, s32, s52
    s_lshl_b32 s33, s54, 16
    s_or_b32 s32, s32, s33
    s_lshl_b32 s33, s55, 24
    s_or_b32 s32, s32, s33
    v_mov_b32 v91, s32
    s_mov_b64 exec, 1
    global_store_dword v11, v91, s[26:27] sc1
    s_mov_b64 exec, -1

L_noep:

    s_branch L_fin
L_ffn:
    s_add_u32 s50, s31, 4
    s_and_b32 s50, s50, 7
    v_lshrrev_b32 v26, 1, v1
    s_cmp_eq_u32 s50, 4
    s_cselect_b32 s33, 15, 31
    v_and_b32 v26, s33, v26
    s_lshl_b32 s32, s50, 5
    v_add_u32 v26, s32, v26
    v_lshlrev_b32 v27, 3, v26
    buffer_load_dwordx2 v[156:157], v27, s[36:39], 0 offen

    s_mov_b64 exec, 1
    ds_add_u32 v2, v3 offset:60
    s_mov_b64 exec, -1

    s_cmp_eq_u32 s31, 7
    s_cbranch_scc0 L_noones
    v_mov_b32 v32, 0x3f803f80
    v_mov_b32 v33, 0x3f803f80
    v_mov_b32 v34, 0x3f803f80
    v_mov_b32 v35, 0x3f803f80
    v_add_u32 v28, 153920, v10
    ds_write_b128 v28, v[32:35]
    s_mov_b64 exec, s[44:45]
    ds_write_b128 v28, v[32:35] offset:1024
    s_mov_b64 exec, -1
L_noones:
    v_add_u32 v12, 131072, v25
    v_add_u32 v13, 0, v25
    v_mov_b32 v14, 152640
    v_mov_b32 v15, 153920
    v_cmp_eq_u32 vcc, 1, v7
    v_and_b32 v16, 7, v7
    v_lshrrev_b32 v16, 2, v16
    v_cndmask_b32 v14, v14, v15, vcc
    v_add_u32 v14, v14, v29
    v_mov_b32 v15, 155712
    v_lshlrev_b32 v16, 6, v16
    v_add_u32 v16, v16, v29
    s_lshr_b32 s33, s31, 2
    s_lshl_b32 s33, s33, 12
    s_add_u32 s33, s33, 65536
    v_add_u32 v17, s33, v25
    v_mov_b32 v18, 0xffff0000
    v_and_b32 v27, 1, v1
    v_mul_u32_u24 v28, 2304, v27
    v_lshl_add_u32 v28, v26, 4, v28
    v_mov_b32 v31, 1048576

    v_add_u32 v30, 0, v27
    v_cmp_eq_u32 vcc, s28, v30
    v_add_u32 v144, 0, v28
    s_nop 0
    v_cndmask_b32 v148, 0, v31, vcc
    v_add_u32 v144, v144, v148
    v_ashrrev_i32 v148, 20, v148

    v_add_u32 v30, 2, v27
    v_cmp_eq_u32 vcc, s28, v30
    v_add_u32 v145, 4608, v28
    s_nop 0
    v_cndmask_b32 v149, 0, v31, vcc
    v_add_u32 v145, v145, v149
    v_ashrrev_i32 v149, 20, v149

    v_add_u32 v30, 4, v27
    v_cmp_eq_u32 vcc, s28, v30
    v_add_u32 v146, 9216, v28
    s_nop 0
    v_cndmask_b32 v150, 0, v31, vcc
    v_add_u32 v146, v146, v150
    v_ashrrev_i32 v150, 20, v150

    v_add_u32 v30, 6, v27
    v_cmp_eq_u32 vcc, s28, v30
    v_add_u32 v147, 13824, v28
    s_nop 0
    v_cndmask_b32 v151, 0, v31, vcc
    v_add_u32 v147, v147, v151
    v_ashrrev_i32 v151, 20, v151

    v_lshrrev_b32 v27, 3, v26
    v_lshlrev_b32 v27, 6, v27
    v_and_b32 v28, 3, v26
    v_lshl_add_u32 v27, v28, 4, v27
    v_bfe_u32 v28, v26, 2, 1
    v_lshl_add_u32 v27, v28, 3, v27
    v_add_u32 v158, 152640, v27
    s_mov_b32 s44, 0x55555555
    s_mov_b32 s45, 0x55555555
    s_cmp_eq_u32 s50, 4
    s_cselect_b32 s45, 0, s45
    s_lshr_b32 s32, s34, 1
    s_mul_i32 s51, s28, 9
    s_add_u32 s51, s51, s32
    s_lshl_b32 s32, s51, 9
    s_and_b32 s33, s34, 1
    s_lshl_b32 s33, s33, 8
    s_add_u32 s36, s32, s33
    s_and_b32 s33, s31, 3
    s_lshl_b32 s33, s33, 6
    s_add_u32 s36, s36, s33
    s_and_b32 s33, s34, 1
    s_lshl_b32 s33, s33, 7
    s_add_u32 s37, s32, s33

    s_add_u32 s8, s26, s36
    s_addc_u32 s9, s27, 0
    s_add_u32 s8, s8, 1015808
    s_addc_u32 s9, s9, 0
    s_add_u32 s10, s8, 1048576
    s_addc_u32 s11, s9, 0
    s_add_u32 s12, s26, s37
    s_addc_u32 s13, s27, 0
    s_add_u32 s12, s12, 2064384
    s_addc_u32 s13, s13, 0
    s_mul_i32 s51, s28, 18
    s_add_u32 s51, s51, s34
    s_mul_i32 s32, s51, 2304
    s_and_b32 s33, s31, 3
    s_lshl_b32 s33, s33, 6
    s_add_u32 s32, s32, s33
    s_lshr_b32 s33, s31, 2
    s_lshl_b32 s33, s33, 8
    s_add_u32 s32, s32, s33

    s_add_u32 s14, s26, s32
    s_addc_u32 s15, s27, 0
    s_add_u32 s14, s14, 655360
    s_addc_u32 s15, s15, 0
    s_add_u32 s48, s26, 524288
    s_addc_u32 s49, s27, 0
    s_mov_b32 s16, 0xaaaaaaaa
    s_mov_b32 s17, 0xaaaaaaaa
    s_mov_b32 s18, 0xcccccccc
    s_mov_b32 s19, 0xcccccccc
    s_waitcnt vmcnt(0) lgkmcnt(0)
    v_lshlrev_b32 v152, 16, v156
    v_and_b32 v153, 0xffff0000, v156
    v_lshlrev_b32 v154, 16, v157
    v_and_b32 v155, 0xffff0000, v157

    s_cmp_lt_u32 s31, 4
    s_cbranch_scc0 L_f1
Lsp_53:
    ds_read_b32 v4, v2 offset:64
    s_waitcnt lgkmcnt(0)
    v_readfirstlane_b32 s59, v4
    s_cmp_ge_u32 s59, 4
    s_cbranch_scc1 Lspx_54
    s_cmp_eq_u32 s57, 0
    s_cbranch_scc1 Lspx_54
    s_sub_u32 s57, s57, 1
    s_sleep 1
    s_branch Lsp_53
Lspx_54:

    ds_read_b64_tr_b16 v[68:69], v12 offset:0
    ds_read_b64_tr_b16 v[70:71], v12 offset:2048
    ds_read_b64_tr_b16 v[72:73], v12 offset:4096
    ds_read_b64_tr_b16 v[74:75], v12 offset:6144
    ds_read_b64_tr_b16 v[76:77], v12 offset:8192
    ds_read_b64_tr_b16 v[78:79], v12 offset:10240
    ds_read_b64_tr_b16 v[80:81], v12 offset:12288
    ds_read_b64_tr_b16 v[82:83], v12 offset:14336
    ds_read_b64_tr_b16 v[84:85], v12 offset:16384
    ds_read_b64_tr_b16 v[86:87], v13 offset:0
    ds_read_b64_tr_b16 v[88:89], v13 offset:2048
    ds_read_b64_tr_b16 v[90:91], v13 offset:4096
    ds_read_b64_tr_b16 v[92:93], v13 offset:6144
    ds_read_b64_tr_b16 v[94:95], v13 offset:8192
    ds_read_b64_tr_b16 v[96:97], v13 offset:10240
    ds_read_b64_tr_b16 v[98:99], v13 offset:12288
Lsp_55:
    ds_read_b32 v4, v2 offset:68
    s_waitcnt lgkmcnt(0)
    v_readfirstlane_b32 s59, v4
    s_cmp_ge_u32 s59, 4
    s_cbranch_scc1 Lspx_56
    s_cmp_eq_u32 s57, 0
    s_cbranch_scc1 Lspx_56
    s_sub_u32 s57, s57, 1
    s_sleep 1
    s_branch Lsp_55
Lspx_56:

    ds_read_b64_tr_b16 v[100:101], v13 offset:14336
    ds_read_b64_tr_b16 v[102:103], v13 offset:16384
    ds_read_b64_tr_b16 v[104:105], v13 offset:18432
    ds_read_b64_tr_b16 v[106:107], v13 offset:20480
    ds_read_b64_tr_b16 v[108:109], v13 offset:22528
    ds_read_b64_tr_b16 v[110:111], v13 offset:24576
    ds_read_b64_tr_b16 v[112:113], v13 offset:26624
    ds_read_b64_tr_b16 v[114:115], v13 offset:28672
    ds_read_b64_tr_b16 v[116:117], v13 offset:30720
    ds_read_b64_tr_b16 v[118:119], v13 offset:32768
    ds_read_b64_tr_b16 v[120:121], v13 offset:34816
    ds_read_b64_tr_b16 v[122:123], v13 offset:36864
L_f1:
    s_cmp_lt_u32 s50, 5
    s_cbranch_scc0 L_f2
Lsp_57:
    ds_read_b32 v4, v2 offset:68
    s_waitcnt lgkmcnt(0)
    v_readfirstlane_b32 s59, v4
    s_cmp_ge_u32 s59, 4
    s_cbranch_scc1 Lspx_58
    s_cmp_eq_u32 s57, 0
    s_cbranch_scc1 Lspx_58
    s_sub_u32 s57, s57, 1
    s_sleep 1
    s_branch Lsp_57
Lspx_58:

    s_mul_i32 s32, s28, 2304
    s_add_u32 s32, s32, 1572864
    v_min_u32 v48, 8, v1
    v_lshlrev_b32 v48, 8, v48
    v_add_u32 v48, s32, v48
    s_mov_b32 s4, 100
L_hpr:
    global_load_dword v49, v48, s[26:27] offset:240 sc1
    s_waitcnt vmcnt(0)
    v_xor_b32 v49, s52, v49
    v_and_b32 v49, 0xff, v49
    v_cmp_ne_u32 vcc, 0, v49
    s_cbranch_vccz L_hprx
    s_cmp_eq_u32 s4, 0
    s_cbranch_scc1 L_hprx
    s_sub_u32 s4, s4, 1
    s_sleep 2
    s_branch L_hpr
L_hprx:

    s_mov_b32 s4, 64
    s_mov_b32 s5, -1048576
Lpl_59:
    global_load_dwordx4 v[32:35], v144, s[48:49] sc1
    global_load_dwordx4 v[36:39], v145, s[48:49] sc1
    global_load_dwordx4 v[40:43], v146, s[48:49] sc1
    global_load_dwordx4 v[44:47], v147, s[48:49] sc1
    s_waitcnt vmcnt(0)
    v_xor_b32 v32, s52, v32
    v_xor_b32 v33, s53, v33
    v_xor_b32 v34, s54, v34
    v_xor_b32 v35, s55, v35
    v_or3_b32 v30, v32, v33, v34
    v_or_b32 v30, v30, v35
    v_xor_b32 v36, s52, v36
    v_xor_b32 v37, s53, v37
    v_xor_b32 v38, s54, v38
    v_xor_b32 v39, s55, v39
    v_or3_b32 v30, v30, v36, v37
    v_or3_b32 v30, v30, v38, v39
    v_xor_b32 v40, s52, v40
    v_xor_b32 v41, s53, v41
    v_xor_b32 v42, s54, v42
    v_xor_b32 v43, s55, v43
    v_or3_b32 v30, v30, v40, v41
    v_or3_b32 v30, v30, v42, v43
    v_xor_b32 v44, s52, v44
    v_xor_b32 v45, s53, v45
    v_xor_b32 v46, s54, v46
    v_xor_b32 v47, s55, v47
    v_or3_b32 v30, v30, v44, v45
    v_or3_b32 v30, v30, v46, v47
    v_and_b32 v30, 0xff, v30
    v_cmp_ne_u32 vcc, 0, v30
    s_cbranch_vccz Lplx_60
    s_cmp_eq_u32 s58, 0
    s_cbranch_scc1 Lplx_60
    s_sub_u32 s58, s58, 1

    s_cmp_eq_u32 s4, 0
    s_cbranch_scc1 Lplt_62
    s_sub_u32 s4, s4, 1
    s_branch Lpl_59
Lplt_62:

    v_mad_i32_i24 v144, v148, s5, v144
    v_mad_i32_i24 v145, v149, s5, v145
    v_mad_i32_i24 v146, v150, s5, v146
    v_mad_i32_i24 v147, v151, s5, v147
    s_sub_u32 s5, 0, s5
    s_branch Lpl_59
Lplx_60:
    v_pk_add_f32 v[32:33], v[32:33], v[36:37]
    v_pk_add_f32 v[34:35], v[34:35], v[38:39]
    v_pk_add_f32 v[40:41], v[40:41], v[44:45]
    v_pk_add_f32 v[42:43], v[42:43], v[46:47]
    v_pk_add_f32 v[32:33], v[32:33], v[40:41]
    v_pk_add_f32 v[34:35], v[34:35], v[42:43]

    s_nop 1
    v_add_f32_dpp v32, v32, v32 quad_perm:[1,0,3,2] row_mask:0xf bank_mask:0xf
    v_add_f32_dpp v33, v33, v33 quad_perm:[1,0,3,2] row_mask:0xf bank_mask:0xf
    v_add_f32_dpp v34, v34, v34 quad_perm:[1,0,3,2] row_mask:0xf bank_mask:0xf
    v_add_f32_dpp v35, v35, v35 quad_perm:[1,0,3,2] row_mask:0xf bank_mask:0xf
    v_cvt_pk_bf16_f32 v36, v32, v33
    v_cvt_pk_bf16_f32 v37, v34, v35
    v_lshlrev_b32 v32, 16, v36
    v_and_b32 v33, 0xffff0000, v36
    v_lshlrev_b32 v34, 16, v37
    v_and_b32 v35, 0xffff0000, v37
    v_pk_add_f32 v[32:33], v[32:33], v[152:153]
    v_pk_add_f32 v[34:35], v[34:35], v[154:155]
    v_cvt_pk_bf16_f32 v36, v32, v33
    v_cvt_pk_bf16_f32 v37, v34, v35
    s_mov_b64 exec, s[44:45]
    ds_write_b64 v158, v[36:37]
    s_mov_b64 exec, -1
    s_waitcnt lgkmcnt(0)

    s_mov_b64 exec, 1
    ds_add_u32 v2, v3 offset:80
    s_mov_b64 exec, -1

    v_lshlrev_b32 v32, 16, v36
    v_and_b32 v33, 0xffff0000, v36
    v_lshlrev_b32 v34, 16, v37
    v_and_b32 v35, 0xffff0000, v37
    v_pk_mul_f32 v[38:39], v[32:33], v[32:33]
    v_pk_add_f32 v[40:41], v[32:33], v[34:35]
    v_pk_fma_f32 v[38:39], v[34:35], v[34:35], v[38:39]
    v_add_f32 v40, v40, v41
    v_add_f32 v38, v38, v39
    v_cndmask_b32 v40, 0, v40, s[44:45]
    v_cndmask_b32 v38, 0, v38, s[44:45]

    s_nop 0
    v_add_f32_dpp v40, v40, v40 row_ror:8 row_mask:0xf bank_mask:0xf
    v_add_f32_dpp v38, v38, v38 row_ror:8 row_mask:0xf bank_mask:0xf
    s_nop 0
    v_add_f32_dpp v40, v40, v40 row_ror:4 row_mask:0xf bank_mask:0xf
    v_add_f32_dpp v38, v38, v38 row_ror:4 row_mask:0xf bank_mask:0xf
    s_nop 0
    v_add_f32_dpp v40, v40, v40 row_ror:2 row_mask:0xf bank_mask:0xf
    v_add_f32_dpp v38, v38, v38 row_ror:2 row_mask:0xf bank_mask:0xf
    s_nop 0
    v_add_f32_dpp v40, v40, v40 row_ror:1 row_mask:0xf bank_mask:0xf
    v_add_f32_dpp v38, v38, v38 row_ror:1 row_mask:0xf bank_mask:0xf
    v_mov_b32 v41, v40
    v_mov_b32 v39, v38
    s_nop 1
    v_permlane16_swap_b32 v41, v40
    v_permlane16_swap_b32 v39, v38
    s_nop 0
    v_add_f32 v40, v40, v41
    v_add_f32 v38, v38, v39
    v_mov_b32 v41, v40
    v_mov_b32 v39, v38
    s_nop 1
    v_permlane32_swap_b32 v41, v40
    v_permlane32_swap_b32 v39, v38
    s_nop 0
    v_add_f32 v40, v40, v41
    v_add_f32 v38, v38, v39
    v_mov_b32 v41, v38
    s_lshl_b32 s32, s50, 3
    s_add_u32 s32, s32, 155712
    v_mov_b32 v42, s32
    s_mov_b64 exec, 1
    ds_write_b64 v42, v[40:41]
    s_mov_b64 exec, -1
    s_waitcnt lgkmcnt(0)

    s_mov_b64 exec, 1
    ds_add_u32 v2, v3 offset:84
    s_mov_b64 exec, -1

L_f2:
    s_cmp_lt_u32 s31, 4
    s_cbranch_scc0 L_f_wd
Lsp_63:
    ds_read_b32 v4, v2 offset:72
    s_waitcnt lgkmcnt(0)
    v_readfirstlane_b32 s59, v4
    s_cmp_ge_u32 s59, 4
    s_cbranch_scc1 Lspx_64
    s_cmp_eq_u32 s57, 0
    s_cbranch_scc1 Lspx_64
    s_sub_u32 s57, s57, 1

    s_branch Lsp_63
Lspx_64:

    ds_read_b64_tr_b16 v[124:125], v13 offset:38912
    ds_read_b64_tr_b16 v[126:127], v13 offset:40960
    ds_read_b64_tr_b16 v[128:129], v13 offset:43008
    ds_read_b64_tr_b16 v[130:131], v13 offset:45056
    ds_read_b64_tr_b16 v[132:133], v13 offset:47104
    ds_read_b64_tr_b16 v[134:135], v13 offset:49152
    ds_read_b64_tr_b16 v[136:137], v13 offset:51200
    ds_read_b64_tr_b16 v[138:139], v13 offset:53248
    s_cmp_eq_u32 s31, 1
    s_cbranch_scc0 L_nogxt
    v_lshlrev_b32 v20, 2, v1
    global_load_dword v21, v20, s[10:11] sc1
L_nogxt:

Lsp_65:
    ds_read_b32 v4, v2 offset:80
    s_waitcnt lgkmcnt(0)
    v_readfirstlane_b32 s59, v4
    s_cmp_ge_u32 s59, 5
    s_cbranch_scc1 Lspx_66
    s_cmp_eq_u32 s57, 0
    s_cbranch_scc1 Lspx_66
    s_sub_u32 s57, s57, 1

    s_branch Lsp_65
Lspx_66:

    ds_read_b128 v[32:35], v14 offset:0
    ds_read_b128 v[36:39], v14 offset:64
    ds_read_b128 v[40:43], v14 offset:128
    ds_read_b128 v[44:47], v14 offset:192
    ds_read_b128 v[48:51], v14 offset:256
    ds_read_b128 v[52:55], v14 offset:320
    ds_read_b128 v[56:59], v14 offset:384
    ds_read_b128 v[60:63], v14 offset:448
    ds_read_b128 v[64:67], v14 offset:512
    s_waitcnt lgkmcnt(8)
    v_mfma_f32_16x16x32_bf16 v[140:143], v[68:71], v[32:35], 0
    ds_read_b128 v[32:35], v14 offset:576
    s_waitcnt lgkmcnt(8)
    v_mfma_f32_16x16x32_bf16 v[140:143], v[72:75], v[36:39], v[140:143]
    ds_read_b128 v[36:39], v14 offset:640
    s_waitcnt lgkmcnt(8)
    v_mfma_f32_16x16x32_bf16 v[140:143], v[76:79], v[40:43], v[140:143]
    ds_read_b128 v[40:43], v14 offset:704
    s_waitcnt lgkmcnt(8)
    v_mfma_f32_16x16x32_bf16 v[140:143], v[80:83], v[44:47], v[140:143]
    ds_read_b128 v[44:47], v14 offset:768
    s_waitcnt lgkmcnt(8)
    v_mfma_f32_16x16x32_bf16 v[140:143], v[84:87], v[48:51], v[140:143]
    ds_read_b128 v[48:51], v14 offset:832
    s_waitcnt lgkmcnt(8)
    v_mfma_f32_16x16x32_bf16 v[140:143], v[88:91], v[52:55], v[140:143]
    ds_read_b128 v[52:55], v14 offset:896
    s_waitcnt lgkmcnt(8)
    v_mfma_f32_16x16x32_bf16 v[140:143], v[92:95], v[56:59], v[140:143]
    ds_read_b128 v[56:59], v14 offset:960
    s_waitcnt lgkmcnt(8)
    v_mfma_f32_16x16x32_bf16 v[140:143], v[96:99], v[60:63], v[140:143]
    ds_read_b128 v[60:63], v14 offset:1024
    s_waitcnt lgkmcnt(8)
    v_mfma_f32_16x16x32_bf16 v[140:143], v[100:103], v[64:67], v[140:143]
    ds_read_b128 v[64:67], v14 offset:1088
    s_waitcnt lgkmcnt(8)
    v_mfma_f32_16x16x32_bf16 v[140:143], v[104:107], v[32:35], v[140:143]
    s_waitcnt lgkmcnt(7)
    v_mfma_f32_16x16x32_bf16 v[140:143], v[108:111], v[36:39], v[140:143]
    s_waitcnt lgkmcnt(6)
    v_mfma_f32_16x16x32_bf16 v[140:143], v[112:115], v[40:43], v[140:143]
    s_waitcnt lgkmcnt(5)
    v_mfma_f32_16x16x32_bf16 v[140:143], v[116:119], v[44:47], v[140:143]
    s_waitcnt lgkmcnt(4)
    v_mfma_f32_16x16x32_bf16 v[140:143], v[120:123], v[48:51], v[140:143]
    s_waitcnt lgkmcnt(3)
    v_mfma_f32_16x16x32_bf16 v[140:143], v[124:127], v[52:55], v[140:143]
    s_waitcnt lgkmcnt(2)
    v_mfma_f32_16x16x32_bf16 v[140:143], v[128:131], v[56:59], v[140:143]
    s_waitcnt lgkmcnt(1)
    v_mfma_f32_16x16x32_bf16 v[140:143], v[132:135], v[60:63], v[140:143]
    s_waitcnt lgkmcnt(0)
    v_mfma_f32_16x16x32_bf16 v[140:143], v[136:139], v[64:67], v[140:143]
Lsp_67:
    ds_read_b32 v4, v2 offset:84
    s_waitcnt lgkmcnt(0)
    v_readfirstlane_b32 s59, v4
    s_cmp_ge_u32 s59, 5
    s_cbranch_scc1 Lspx_68
    s_cmp_eq_u32 s57, 0
    s_cbranch_scc1 Lspx_68
    s_sub_u32 s57, s57, 1

    s_branch Lsp_67
Lspx_68:

    ds_read_b128 v[32:35], v15
    ds_read_b128 v[36:39], v15 offset:16
    ds_read_b64 v[40:41], v15 offset:32
    s_waitcnt lgkmcnt(0)
    v_pk_add_f32 v[32:33], v[32:33], v[34:35]
    v_pk_add_f32 v[36:37], v[36:37], v[38:39]
    v_pk_add_f32 v[32:33], v[32:33], v[40:41]
    v_pk_add_f32 v[32:33], v[32:33], v[36:37]
    v_mul_f32 v36, 0x3ae38e39, v32
    v_mul_f32 v37, 0x3ae38e39, v33
    v_fma_f32 v37, -v36, v36, v37
    v_max_f32 v37, 0, v37
    v_cvt_pk_bf16_f32 v38, v36, v37
    v_lshlrev_b32 v36, 16, v38
    v_and_b32 v37, 0xffff0000, v38
    v_add_f32 v37, 0x3727c5ac, v37
    v_cvt_pk_bf16_f32 v38, v37, v37
    v_and_b32 v37, 0xffff0000, v38
    v_sqrt_f32 v37, v37
    s_nop 0
    v_cvt_pk_bf16_f32 v38, v37, v37
    v_and_b32 v37, 0xffff0000, v38
    v_rcp_f32 v37, v37
    v_mov_b32_dpp v32, v140 quad_perm:[1,1,1,1] row_mask:0xf bank_mask:0xf
    v_mov_b32_dpp v33, v141 quad_perm:[1,1,1,1] row_mask:0xf bank_mask:0xf
    v_mov_b32_dpp v34, v142 quad_perm:[1,1,1,1] row_mask:0xf bank_mask:0xf
    v_mov_b32_dpp v35, v143 quad_perm:[1,1,1,1] row_mask:0xf bank_mask:0xf
    v_fma_f32 v140, -v36, v32, v140
    v_fma_f32 v141, -v36, v33, v141
    v_fma_f32 v142, -v36, v34, v142
    v_fma_f32 v143, -v36, v35, v143
    v_mul_f32 v140, v140, v37
    v_mul_f32 v141, v141, v37
    v_mul_f32 v142, v142, v37
    v_mul_f32 v143, v143, v37
    v_cvt_pk_bf16_f32 v32, v140, v141
    v_cvt_pk_bf16_f32 v33, v142, v143
    v_lshl_or_b32 v140, v32, 16, s52
    v_and_or_b32 v141, v32, v18, s53
    v_lshl_or_b32 v142, v33, 16, s54
    v_and_or_b32 v143, v33, v18, s55
    s_mov_b64 exec, s[40:41]

    global_store_dwordx4 v29, v[140:143], s[10:11]
    s_cmp_eq_u32 s20, 1
    s_cbranch_scc1 Lds_69
    global_store_dwordx4 v29, v[140:143], s[8:9] sc1
Lds_69:
    s_mov_b64 exec, -1
L_f_wd:
    global_load_dwordx4 v[32:35], v16, s[12:13] sc1
    global_load_dwordx4 v[36:39], v16, s[12:13] offset:256 sc1
Lsp_70:
    ds_read_b32 v4, v2 offset:76
    s_waitcnt lgkmcnt(0)
    v_readfirstlane_b32 s59, v4
    s_cmp_ge_u32 s59, 4
    s_cbranch_scc1 Lspx_71
    s_cmp_eq_u32 s57, 0
    s_cbranch_scc1 Lspx_71
    s_sub_u32 s57, s57, 1

    s_branch Lsp_70
Lspx_71:

    ds_read_b64_tr_b16 v[68:69], v17 offset:0
    ds_read_b64_tr_b16 v[70:71], v17 offset:2048
    ds_read_b64_tr_b16 v[72:73], v17 offset:8192
    ds_read_b64_tr_b16 v[74:75], v17 offset:10240
    ds_read_b64_tr_b16 v[76:77], v17 offset:16384
    ds_read_b64_tr_b16 v[78:79], v17 offset:18432
    ds_read_b64_tr_b16 v[80:81], v17 offset:24576
    ds_read_b64_tr_b16 v[82:83], v17 offset:26624
    ds_read_b64_tr_b16 v[84:85], v17 offset:32768
    ds_read_b64_tr_b16 v[86:87], v17 offset:34816
    s_mov_b32 s4, 64
    s_mov_b32 s5, -1048576
    s_branch Lplp_74
Lpl_72:
    global_load_dwordx4 v[32:35], v16, s[12:13] sc1
    global_load_dwordx4 v[36:39], v16, s[12:13] offset:256 sc1
Lplp_74:
    s_waitcnt vmcnt(0)
    v_xor_b32 v32, s52, v32
    v_xor_b32 v33, s53, v33
    v_xor_b32 v34, s54, v34
    v_xor_b32 v35, s55, v35
    v_or3_b32 v30, v32, v33, v34
    v_or_b32 v30, v30, v35
    v_xor_b32 v36, s52, v36
    v_xor_b32 v37, s53, v37
    v_xor_b32 v38, s54, v38
    v_xor_b32 v39, s55, v39
    v_or3_b32 v30, v30, v36, v37
    v_or3_b32 v30, v30, v38, v39
    v_and_b32 v30, 0xff, v30
    v_cmp_ne_u32 vcc, 0, v30
    s_cbranch_vccz Lplx_73
    s_cmp_eq_u32 s58, 0
    s_cbranch_scc1 Lplx_73
    s_sub_u32 s58, s58, 1

    s_cmp_eq_u32 s4, 0
    s_cbranch_scc1 Lplt_75
    s_sub_u32 s4, s4, 1
    s_branch Lpl_72
Lplt_75:

    s_ashr_i32 s6, s5, 31
    s_add_u32 s12, s12, s5
    s_addc_u32 s13, s13, s6
    s_sub_u32 s5, 0, s5
    s_branch Lpl_72
Lplx_73:
    v_cndmask_b32 v32, v32, v33, s[16:17]
    v_cndmask_b32 v34, v34, v35, s[16:17]
    v_cndmask_b32 v36, v36, v37, s[16:17]
    v_cndmask_b32 v38, v38, v39, s[16:17]
    v_cndmask_b32 v32, v32, v34, s[18:19]
    v_cndmask_b32 v36, v36, v38, s[18:19]
    v_mul_f32 v32, v32, v36
    s_nop 1
    v_mov_b32_dpp v33, v32 quad_perm:[1,1,3,3] row_mask:0xf bank_mask:0xf
    v_cvt_pk_bf16_f32 v40, v32, v33
    s_nop 1
    v_mov_b32_dpp v41, v40 row_shl:2 row_mask:0xf bank_mask:0xf
    v_mov_b32_dpp v42, v40 row_shl:4 row_mask:0xf bank_mask:0xf
    v_mov_b32_dpp v43, v40 row_shl:6 row_mask:0xf bank_mask:0xf
    s_waitcnt lgkmcnt(0)

    s_nop 0
    v_mfma_f32_16x16x32_bf16 v[88:91], v[68:71], v[40:43], 0
    v_mfma_f32_16x16x32_bf16 v[92:95], v[72:75], v[40:43], 0
    v_mfma_f32_16x16x32_bf16 v[96:99], v[76:79], v[40:43], 0
    v_mfma_f32_16x16x32_bf16 v[100:103], v[80:83], v[40:43], 0
    v_mfma_f32_16x16x32_bf16 v[104:107], v[84:87], v[40:43], 0
    s_and_b32 s33, s31, 3
    s_lshl_b32 s33, s33, 6
    s_lshr_b32 s32, s31, 2
    s_lshl_b32 s32, s32, 8
    s_add_u32 s33, s33, s32
    s_add_u32 s33, s33, 155776
    v_add_u32 v30, s33, v29
    v_add_u32 v31, 155776, v10
    s_lshl_b32 s32, s31, 10
    v_add_u32 v31, s32, v31
    s_mul_i32 s32, s51, 2304
    s_lshl_b32 s33, s31, 10
    s_add_u32 s32, s32, s33

    s_add_u32 s14, s26, s32
    s_addc_u32 s15, s27, 0
    s_add_u32 s14, s14, 655360
    s_addc_u32 s15, s15, 0
    s_mov_b64 exec, s[40:41]
    ds_write_b128 v30, v[88:91] offset:0
    ds_write_b128 v30, v[92:95] offset:512
    ds_write_b128 v30, v[96:99] offset:1024
    ds_write_b128 v30, v[100:103] offset:1536
    s_cmp_lt_u32 s31, 4
    s_cbranch_scc0 L_ffn_e
    ds_write_b128 v30, v[104:107] offset:2048
L_ffn_e:
    s_mov_b64 exec, -1
    s_waitcnt lgkmcnt(0)
    s_barrier
    s_cmp_lt_u32 s31, 3
    s_cbranch_scc0 L_ffn_x
    ds_read_b128 v[32:35], v31
    s_waitcnt lgkmcnt(0)

    v_bfi_b32 v32, v5, s52, v32
    v_bfi_b32 v33, v5, s53, v33
    v_bfi_b32 v34, v5, s54, v34
    v_bfi_b32 v35, v5, s55, v35
    s_mov_b64 s[16:17], -1
    s_mov_b64 s[18:19], 0xffff
    s_cmp_eq_u32 s31, 2
    s_cselect_b64 s[16:17], s[18:19], s[16:17]
    s_mov_b64 exec, s[16:17]
    global_store_dwordx4 v10, v[32:35], s[14:15] sc1
    s_mov_b64 exec, -1
L_ffn_x:

L_fin:
L_end:
    s_endpgm
.section .rodata,"a"
.p2align 6
.amdhsa_kernel sequential_preLN__sliding_block_cached__glu_gated_bilinear__decode_kernel
  .amdhsa_next_free_vgpr 160
  .amdhsa_next_free_sgpr 100
  .amdhsa_accum_offset 160
  .amdhsa_group_segment_fixed_size 0
  .amdhsa_kernarg_size 96
  .amdhsa_user_sgpr_count 2
  .amdhsa_user_sgpr_kernarg_segment_ptr 1
  .amdhsa_system_sgpr_workgroup_id_x 1
  .amdhsa_float_denorm_mode_32 3
.end_amdhsa_kernel
```
